```python
import torch

def _softmax(x, axis=-1):
    return torch.softmax(x, dim=axis)
def _gelu(x):
    return torch.nn.functional.gelu(x, approximate="tanh")
def _silu(x):
    return torch.nn.functional.silu(x)
def _sigmoid(x):
    return torch.sigmoid(x)
def _layernorm(x, axis=-1, eps=1e-5):
    m = x.mean(dim=axis, keepdim=True)
    v = x.var(dim=axis, keepdim=True, unbiased=False)
    return (x - m) / torch.sqrt(v + eps)
def _scatter_add(tgt, idx, src, axis=0):
    return tgt.clone().index_add_(axis, idx, src)
def _segment_sum(src, seg, n):
    out = torch.zeros((n,) + src.shape[1:], dtype=src.dtype)
    return out.index_add_(0, seg, src)
def _pad(x, pw):
    flat = tuple(v for pair in reversed(pw) for v in pair)
    return torch.nn.functional.pad(x, flat)

kernel_name = 'concat_heads__ssm_conv_s5__grouped_kv_mqa__prompt'

def setup_inputs():

    _w = (lambda a: (lambda t: t.to(torch.bfloat16) if t.is_floating_point() else t)(torch.as_tensor(a)))
    def _A_setup():
        B, S, D = 1, 2048, 1024
        P = D
        Lambda_re = -0.5 * (lambda _x: torch.exp(torch.as_tensor(_x)))((lambda *s: torch.randn(*s, dtype=torch.bfloat16) * 0.4)(P))
        Lambda_im = (lambda *s: torch.randn(*s, dtype=torch.bfloat16) * 0.4)(P) * 1.0
        B_re = (lambda *s: torch.randn(*s, dtype=torch.bfloat16) * 0.4)(P, D) * (D ** -0.5)
        B_im = (lambda *s: torch.randn(*s, dtype=torch.bfloat16) * 0.4)(P, D) * (D ** -0.5)
        C_re = (lambda *s: torch.randn(*s, dtype=torch.bfloat16) * 0.4)(D, P) * (P ** -0.5)
        C_im = (lambda *s: torch.randn(*s, dtype=torch.bfloat16) * 0.4)(D, P) * (P ** -0.5)
        log_dt = (lambda *s: torch.randn(*s, dtype=torch.bfloat16) * 0.4)(P) * 0.3 - 2.0
        Dskip = (lambda *s: torch.randn(*s, dtype=torch.bfloat16) * 0.05)(D)
        return {
            "x": _w((lambda *s: torch.randn(*s, dtype=torch.bfloat16) * 0.05)(B, S, D)),
            "Lambda_re": _w(Lambda_re),
            "Lambda_im": _w(Lambda_im),
            "B_re": _w(B_re),
            "B_im": _w(B_im),
            "C_re": _w(C_re),
            "C_im": _w(C_im),
            "log_dt": _w(log_dt),
            "Dskip": _w(Dskip),
        }
    _A_in = _A_setup()

    def _B_setup():
        B, S, D, H = 1, 2048, 1024, 32
        Dh = D // H
        return {
            "x": _w((lambda *s: torch.randn(*s, dtype=torch.bfloat16) * 0.05)(B, S, D)),
            "wq": _w((lambda *s: torch.randn(*s, dtype=torch.bfloat16) * 0.8)(D, H * Dh)),
            "wk": _w((lambda *s: torch.randn(*s, dtype=torch.bfloat16) * 0.8)(D, Dh)),
            "wv": _w((lambda *s: torch.randn(*s, dtype=torch.bfloat16) * 0.05)(D, Dh)),
            "wo": _w((lambda *s: torch.randn(*s, dtype=torch.bfloat16) * 0.05)(H * Dh, D)),
        }
    _B_in = _B_setup()

    return {
        "A_x": _A_in["x"],
        "A_Lambda_re": _A_in["Lambda_re"],
        "A_Lambda_im": _A_in["Lambda_im"],
        "A_B_re": _A_in["B_re"],
        "A_B_im": _A_in["B_im"],
        "A_C_re": _A_in["C_re"],
        "A_C_im": _A_in["C_im"],
        "A_log_dt": _A_in["log_dt"],
        "A_Dskip": _A_in["Dskip"],
        "B_x": _B_in["x"],
        "B_wq": _B_in["wq"],
        "B_wk": _B_in["wk"],
        "B_wv": _B_in["wv"],
        "B_wo": _B_in["wo"],
    }

def reference(A_x, A_Lambda_re, A_Lambda_im, A_B_re, A_B_im, A_C_re, A_C_im, A_log_dt, A_Dskip, B_x, B_wq, B_wk, B_wv, B_wo):
    def _A_ref(x, Lambda_re, Lambda_im, B_re, B_im, C_re, C_im, log_dt, Dskip):
        Bsz, L, H = x.shape
        Lam = Lambda_re + 1j * Lambda_im
        Bmat = B_re + 1j * B_im
        Cmat = C_re + 1j * C_im
        dt = torch.exp(log_dt)
        Lam_bar = torch.exp(dt * Lam)
        B_bar = ((Lam_bar - 1.0) / Lam)[:, None] * Bmat
        Bu = torch.einsum("bld,pd->blp", x + 0j, B_bar)
        h = torch.zeros_like(Bu[:, 0, :])
        hs = []
        for t in range(L):
            h = Lam_bar[None, :] * h + Bu[:, t, :]
            hs.append(h)
        hseq = torch.stack(hs, 1)
        y = 2.0 * torch.einsum("blp,dp->bld", hseq, Cmat).real + x * Dskip[None, None, :]
        return y

    def _B_ref(x, wq, wk, wv, wo):
        B, S, D = x.shape
        H = 32
        Dh = D // H
        q = (lambda x, *d: x.permute(*d))((x @ wq).reshape(B, S, H, Dh), 0, 2, 1, 3)
        k = x @ wk
        v = x @ wv
        scores = torch.einsum("bhqd,bkd->bhqk", q, k) * (Dh ** -0.5)
        p = _softmax(scores, axis=-1)
        o = torch.einsum("bhqk,bkd->bhqd", p, v)
        return (lambda x, *d: x.permute(*d))(o, 0, 2, 1, 3).reshape(B, S, H * Dh) @ wo

    a = _A_ref(A_x, A_Lambda_re, A_Lambda_im, A_B_re, A_B_im, A_C_re, A_C_im, A_log_dt, A_Dskip)
    b = _B_ref(B_x, B_wq, B_wk, B_wv, B_wo)
    return torch.concatenate([a, b], axis=-1)
```

```asm
; @launch grid=(256,1,1) block=(512,1,1) lds=163840
.amdgcn_target "amdgcn-amd-amdhsa--gfx950"
.text
.globl concat_heads__ssm_conv_s5__grouped_kv_mqa__prompt_kernel
.p2align 8
.type concat_heads__ssm_conv_s5__grouped_kv_mqa__prompt_kernel,@function
concat_heads__ssm_conv_s5__grouped_kv_mqa__prompt_kernel:
    s_cmp_ge_u32 s2, 256
    s_cbranch_scc1 L_exit
    s_load_dwordx16 s[4:19], s[0:1], 0
    s_load_dwordx16 s[20:35], s[0:1], 64
    s_load_dwordx2 s[36:37], s[0:1], 128
    v_lshrrev_b32 v1, 6, v0
    v_and_b32 v0, 63, v0
    v_readfirstlane_b32 s38, v1
    s_lshr_b32 s83, s2, 3
    s_and_b32 s86, s2, 1
    s_bfe_u32 s69, s2, 0x20001
    s_and_b32 s3, s83, 7
    s_lshr_b32 s78, s83, 3
    s_lshl2_add_u32 s39, s69, s78
    s_and_b32 s68, s39, 7
    s_lshr_b32 s69, s69, 1
    s_lshl3_add_u32 s69, s69, s3
    s_and_b32 s81, s38, 3
    s_getpc_b64 s[100:101]
L_pc:
    s_mul_i32 s79, s83, 768
    s_mul_i32 s80, s86, L_group2-L_pc
    s_add_u32 s79, s79, s80
    v_min_u32 v2, 5, v0
    v_lshl_add_u32 v2, v2, 7, s79
    v_min_u32 v2, L_exit-L_pc, v2
    s_cmp_lg_u32 s38, 6
    s_cbranch_scc1 L_sk_1
    global_load_dword v31, v2, s[100:101]
L_sk_1:
    s_lshl3_add_u32 s77, s86, s38
    s_lshr_b32 s70, s77, 2
    s_cmp_eq_u32 s70, 2
    s_cbranch_scc1 L_group2
    s_lshl_b32 s75, s38, 14
    s_cmp_eq_u32 s70, 1
    s_cbranch_scc1 L_g1hi_pre
L_first:
    s_lshr_b32 s78, s3, 1
    s_add_u32 s67, s39, s3
    s_and_b32 s67, s67, 1
    s_lshl_b32 s79, s81, 12
    s_lshl_b32 s71, s38, 8
    s_lshl_b32 s80, s67, 7
    s_lshl_b32 s73, s86, 14
    s_cmov_b32 s78, s81
    s_cmov_b32 s75, s79
    s_cmov_b32 s71, s80
    s_lshl2_add_u32 s66, s39, s78
    s_lshl_b32 s78, s66, 5
    v_lshrrev_b32 v1, 3, v0
    v_and_b32 v2, 7, v0
    v_lshrrev_b32 v3, 1, v1
    v_xor_b32 v2, v2, v3
    v_add_lshl_u32 v1, v1, s78, 11
    v_lshl_add_u32 v48, v2, 4, v1
    v_xor_b32 v1, 64, v48
    v_add_u32 v49, 15360, v1
    v_add_u32 v50, 30720, v48
    v_add_u32 v51, 46080, v1
    s_mov_b32 s46, 0x400000
    s_mov_b32 s47, 0x20000
    s_waitcnt lgkmcnt(0)
    s_mov_b64 s[44:45], s[22:23]
    s_add_u32 m0, s75, s73
    s_nop 0
    buffer_load_dwordx4 v48, s[44:47], s71 offen offset:0 lds
    buffer_load_dwordx4 v49, s[44:47], s71 offen offset:1024 lds
    buffer_load_dwordx4 v50, s[44:47], s71 offen offset:2048 lds
    buffer_load_dwordx4 v51, s[44:47], s71 offen offset:3072 lds
    s_lshl_b32 s78, s3, 8
    v_lshrrev_b32 v1, 4, v0
    v_and_b32 v2, 15, v0
    v_lshlrev_b32 v3, 1, v1
    v_xor_b32 v2, v2, v3
    s_lshl_b32 s77, s81, 4
    v_add_lshl_u32 v1, v1, s77, 11
    v_lshl_add_u32 v1, v2, 4, v1
    v_add_u32 v52, s78, v1
    v_xor_b32 v1, 0x80, v52
    v_add_u32 v53, 7168, v52
    v_add_u32 v54, 14336, v1
    v_add_u32 v55, 21504, v1
    s_bitcmp1_b32 s3, 0
    s_cselect_b64 s[48:49], s[28:29], s[26:27]
    s_mov_b32 s50, 0x10000
    s_mov_b32 s51, 0x20000
    s_lshl_b32 s72, s38, 13
    s_lshl_b32 s77, s67, 17
    s_movk_i32 s74, 0x2000
    s_movk_i32 s82, 0x1000
    s_movk_i32 s85, 0x1000
    s_cmp_lg_u32 s86, 0
    s_cselect_b64 vcc, -1, 0
    s_cselect_b64 s[48:49], s[24:25], s[48:49]
    s_cmov_b32 s50, 0x200000
    s_cmov_b32 s72, s77
    s_cmovk_i32 s74, 0
    s_cmov_b32 s82, 0x8000
    s_cmov_b32 s85, 0x20000
    v_lshlrev_b32 v1, 4, v0
    v_cndmask_b32 v52, v1, v52, vcc
    v_cndmask_b32 v53, v1, v53, vcc
    v_cndmask_b32 v54, v1, v54, vcc
    v_cndmask_b32 v55, v1, v55, vcc
    s_add_u32 m0, s75, s74
    s_nop 0
    buffer_load_dwordx4 v52, s[48:51], s72 offen offset:0 lds
    buffer_load_dwordx4 v53, s[48:51], s72 offen offset:1024 lds
    buffer_load_dwordx4 v54, s[48:51], s72 offen offset:2048 lds
    buffer_load_dwordx4 v55, s[48:51], s72 offen offset:3072 lds
    s_xor_b32 s71, s71, 128
    s_xor_b32 s72, s72, s85
    s_add_u32 s73, s73, s82
    s_add_u32 s74, s74, s82
    s_add_u32 m0, s75, s73
    s_nop 0
    buffer_load_dwordx4 v48, s[44:47], s71 offen offset:0 lds
    buffer_load_dwordx4 v49, s[44:47], s71 offen offset:1024 lds
    buffer_load_dwordx4 v50, s[44:47], s71 offen offset:2048 lds
    buffer_load_dwordx4 v51, s[44:47], s71 offen offset:3072 lds
    s_add_u32 m0, s75, s74
    s_nop 0
    buffer_load_dwordx4 v52, s[48:51], s72 offen offset:0 lds
    buffer_load_dwordx4 v53, s[48:51], s72 offen offset:1024 lds
    buffer_load_dwordx4 v54, s[48:51], s72 offen offset:2048 lds
    buffer_load_dwordx4 v55, s[48:51], s72 offen offset:3072 lds
    s_cmp_lg_u32 s86, 0
    s_cbranch_scc1 L_g2hi
    s_cmp_ge_u32 s38, 4
    s_cbranch_scc1 L_g1x_4
    v_mov_b32 v24, 0
    v_mov_b32 v25, 0
    v_mov_b32 v26, 0
    v_mov_b32 v27, 0
    v_mov_b32 v29, 0
    s_mov_b32 s40, s36
    s_mov_b32 s41, s37
    s_mov_b32 s42, 0x10000000
    s_mov_b32 s43, 0x20000
    s_mov_b32 s56, s32
    s_mov_b32 s57, s33
    s_mov_b32 s58, 0x1000000
    s_mov_b32 s59, 0x20000
    s_mov_b32 s60, s34
    s_mov_b32 s61, s35
    s_mov_b32 s62, 0x100
    s_mov_b32 s63, 0x20000
    v_and_b32 v1, 31, v0
    v_lshrrev_b32 v2, 5, v0
    v_bfe_u32 v3, v0, 1, 3
    v_xor_b32 v2, v2, v3
    v_lshlrev_b32 v2, 4, v2
    v_lshl_add_u32 v2, v1, 7, v2
    v_add_u32 v56, s75, v2
    v_xor_b32 v57, 32, v56
    v_xor_b32 v58, 64, v56
    v_xor_b32 v59, 96, v56
    s_and_b32 s78, s3, 1
    s_sub_u32 s79, s78, 1
    v_bfe_u32 v1, v0, 2, 2
    v_lshrrev_b32 v2, 5, v0
    v_lshl_add_u32 v1, v2, 3, v1
    v_bfe_u32 v2, v0, 4, 1
    v_lshlrev_b32 v2, 5, v2
    v_lshl_add_u32 v1, v1, 6, v2
    v_lshrrev_b32 v2, 1, v0
    v_xor_b32 v2, v2, v0
    v_and_b32 v2, 1, v2
    v_mul_u32_u24 v2, 3, v2
    v_and_b32 v2, s79, v2
    v_xor_b32 v2, v2, v0
    v_and_b32 v2, 3, v2
    v_lshl_add_u32 v1, v2, 3, v1
    v_add_u32 v60, s75, v1
    s_lshl_b32 s77, s81, 12
    s_add_u32 s77, s77, 0x24000
    v_lshl_add_u32 v61, v0, 4, s77
    v_mfma_f32_32x32x16_bf16 v[32:47], v[24:27], v[24:27], 0
    s_lshr_b32 s79, s81, 1
    s_lshl1_add_u32 s78, s68, s79
    s_and_b32 s80, s81, 1
    s_lshl4_add_u32 s78, s78, s80
    s_lshl_b32 s78, s78, 3
    v_lshrrev_b32 v1, 3, v0
    v_and_b32 v2, 7, v0
    v_lshrrev_b32 v3, 1, v1
    v_xor_b32 v2, v2, v3
    v_and_b32 v3, 1, v3
    v_and_b32 v1, 1, v1
    v_lshl_add_u32 v1, v1, 4, v3
    v_and_b32 v3, 32, v0
    v_add_u32 v1, v1, v3
    v_add_lshl_u32 v1, v1, s78, 11
    v_lshl_add_u32 v8, v2, 4, v1
    v_xor_b32 v1, 64, v8
    v_add_u32 v9, 130048, v1
    v_add_u32 v10, 2048, v8
    v_add_u32 v11, 132096, v1
    s_lshl1_add_u32 s78, s69, s79
    s_lshl_b32 s78, s78, 5
    v_lshrrev_b32 v1, 3, v0
    v_and_b32 v2, 7, v0
    v_lshrrev_b32 v3, 1, v1
    v_xor_b32 v2, v2, v3
    v_add_lshl_u32 v1, v1, s78, 11
    v_lshl_add_u32 v12, v2, 4, v1
    v_xor_b32 v1, 64, v12
    v_add_u32 v13, 15360, v1
    v_add_u32 v14, 30720, v12
    v_add_u32 v15, 46080, v1
    s_lshl_b32 s73, s81, 13
    s_lshl_b32 s74, s81, 12
    s_add_u32 s74, s74, 32768
    s_add_u32 s67, s73, 4096
    s_mov_b32 s71, 0
    s_mov_b32 s75, 0
    s_mov_b32 s44, s4
    s_mov_b32 s45, s5
    s_mov_b32 s46, 0x400000
    s_mov_b32 s47, 0x20000
    s_bitcmp1_b32 s38, 0
    s_cselect_b64 s[48:49], s[12:13], s[10:11]
    s_mov_b32 s50, 0x200000
    s_mov_b32 s51, 0x20000
L_g1kv_5:
    s_bitcmp1_b32 s3, 0
    s_cbranch_scc1 L_kvv_6
    s_waitcnt vmcnt(12)
    ds_read_b128 v[64:67], v56 offset:0
    ds_read_b128 v[68:71], v57 offset:0
    ds_read_b128 v[72:75], v58 offset:0
    ds_read_b128 v[76:79], v59 offset:0
    s_waitcnt vmcnt(8) lgkmcnt(0)
    ds_read_b64_tr_b16 v[96:97], v60 offset:8192
    ds_read_b64_tr_b16 v[98:99], v60 offset:8448
    ds_read_b64_tr_b16 v[100:101], v60 offset:9216
    ds_read_b64_tr_b16 v[102:103], v60 offset:9472
    ds_read_b64_tr_b16 v[104:105], v60 offset:10240
    ds_read_b64_tr_b16 v[106:107], v60 offset:10496
    ds_read_b64_tr_b16 v[108:109], v60 offset:11264
    ds_read_b64_tr_b16 v[110:111], v60 offset:11520
    s_waitcnt lgkmcnt(6)
    v_mfma_f32_32x32x16_bf16 v[32:47], v[96:99], v[64:67], v[32:47]
    s_waitcnt lgkmcnt(4)
    v_mfma_f32_32x32x16_bf16 v[32:47], v[100:103], v[68:71], v[32:47]
    s_waitcnt lgkmcnt(2)
    v_mfma_f32_32x32x16_bf16 v[32:47], v[104:107], v[72:75], v[32:47]
    s_waitcnt lgkmcnt(0)
    v_mfma_f32_32x32x16_bf16 v[32:47], v[108:111], v[76:79], v[32:47]
    s_waitcnt vmcnt(4)
    ds_read_b128 v[80:83], v56 offset:4096
    ds_read_b128 v[84:87], v57 offset:4096
    ds_read_b128 v[88:91], v58 offset:4096
    ds_read_b128 v[92:95], v59 offset:4096
    s_waitcnt vmcnt(0) lgkmcnt(0)
    ds_read_b64_tr_b16 v[112:113], v60 offset:12288
    ds_read_b64_tr_b16 v[114:115], v60 offset:12544
    ds_read_b64_tr_b16 v[116:117], v60 offset:13312
    ds_read_b64_tr_b16 v[118:119], v60 offset:13568
    ds_read_b64_tr_b16 v[120:121], v60 offset:14336
    ds_read_b64_tr_b16 v[122:123], v60 offset:14592
    ds_read_b64_tr_b16 v[124:125], v60 offset:15360
    ds_read_b64_tr_b16 v[126:127], v60 offset:15616
    s_waitcnt lgkmcnt(6)
    v_mfma_f32_32x32x16_bf16 v[32:47], v[112:115], v[80:83], v[32:47]
    s_waitcnt lgkmcnt(4)
    v_mfma_f32_32x32x16_bf16 v[32:47], v[116:119], v[84:87], v[32:47]
    s_waitcnt lgkmcnt(2)
    v_mfma_f32_32x32x16_bf16 v[32:47], v[120:123], v[88:91], v[32:47]
    s_waitcnt lgkmcnt(0)
    v_mfma_f32_32x32x16_bf16 v[32:47], v[124:127], v[92:95], v[32:47]
    s_branch L_kvj_7
L_kvv_6:
    s_waitcnt vmcnt(12)
    ds_read_b128 v[64:67], v56 offset:0
    ds_read_b128 v[68:71], v57 offset:0
    ds_read_b128 v[72:75], v58 offset:0
    ds_read_b128 v[76:79], v59 offset:0
    s_waitcnt vmcnt(8) lgkmcnt(0)
    ds_read_b64_tr_b16 v[96:97], v60 offset:8192
    ds_read_b64_tr_b16 v[98:99], v60 offset:8448
    ds_read_b64_tr_b16 v[100:101], v60 offset:9216
    ds_read_b64_tr_b16 v[102:103], v60 offset:9472
    ds_read_b64_tr_b16 v[104:105], v60 offset:10240
    ds_read_b64_tr_b16 v[106:107], v60 offset:10496
    ds_read_b64_tr_b16 v[108:109], v60 offset:11264
    ds_read_b64_tr_b16 v[110:111], v60 offset:11520
    s_waitcnt lgkmcnt(6)
    v_mfma_f32_32x32x16_bf16 v[32:47], v[64:67], v[96:99], v[32:47]
    s_waitcnt lgkmcnt(4)
    v_mfma_f32_32x32x16_bf16 v[32:47], v[68:71], v[100:103], v[32:47]
    s_waitcnt lgkmcnt(2)
    v_mfma_f32_32x32x16_bf16 v[32:47], v[72:75], v[104:107], v[32:47]
    s_waitcnt lgkmcnt(0)
    v_mfma_f32_32x32x16_bf16 v[32:47], v[76:79], v[108:111], v[32:47]
    s_waitcnt vmcnt(4)
    ds_read_b128 v[80:83], v56 offset:4096
    ds_read_b128 v[84:87], v57 offset:4096
    ds_read_b128 v[88:91], v58 offset:4096
    ds_read_b128 v[92:95], v59 offset:4096
    s_waitcnt vmcnt(0) lgkmcnt(0)
    ds_read_b64_tr_b16 v[112:113], v60 offset:12288
    ds_read_b64_tr_b16 v[114:115], v60 offset:12544
    ds_read_b64_tr_b16 v[116:117], v60 offset:13312
    ds_read_b64_tr_b16 v[118:119], v60 offset:13568
    ds_read_b64_tr_b16 v[120:121], v60 offset:14336
    ds_read_b64_tr_b16 v[122:123], v60 offset:14592
    ds_read_b64_tr_b16 v[124:125], v60 offset:15360
    ds_read_b64_tr_b16 v[126:127], v60 offset:15616
    s_waitcnt lgkmcnt(6)
    v_mfma_f32_32x32x16_bf16 v[32:47], v[80:83], v[112:115], v[32:47]
    s_waitcnt lgkmcnt(4)
    v_mfma_f32_32x32x16_bf16 v[32:47], v[84:87], v[116:119], v[32:47]
    s_waitcnt lgkmcnt(2)
    v_mfma_f32_32x32x16_bf16 v[32:47], v[88:91], v[120:123], v[32:47]
    s_waitcnt lgkmcnt(0)
    v_mfma_f32_32x32x16_bf16 v[32:47], v[92:95], v[124:127], v[32:47]
L_kvj_7:
    s_nop 11
    ds_write_b128 v61, v[32:35] offset:0
    ds_write_b128 v61, v[36:39] offset:1024
    ds_write_b128 v61, v[40:43] offset:2048
    ds_write_b128 v61, v[44:47] offset:3072
    s_waitcnt lgkmcnt(0)
    s_barrier
    s_cmp_ge_u32 s38, 4
    s_cbranch_scc1 L_g1hi_2
    s_cmp_lg_u32 s38, 2
    s_cbranch_scc1 L_sk_8
    s_lshl_b32 s77, s69, 7
    v_lshl_add_u32 v1, v0, 1, s77
    global_load_ushort v68, v1, s[6:7]
    global_load_ushort v69, v1, s[8:9]
    global_load_ushort v67, v1, s[18:19]
L_sk_8:
    s_add_u32 s72, s71, 0x2000
    s_add_u32 m0, s75, s74
    s_nop 0
    buffer_load_dwordx4 v12, s[48:51], s71 offen offset:0 lds
    buffer_load_dwordx4 v13, s[48:51], s71 offen offset:1024 lds
    buffer_load_dwordx4 v14, s[48:51], s71 offen offset:2048 lds
    buffer_load_dwordx4 v15, s[48:51], s71 offen offset:3072 lds
    s_add_u32 m0, s75, s73
    s_nop 0
    buffer_load_dwordx4 v8, s[44:47], s71 offen offset:0 lds
    buffer_load_dwordx4 v9, s[44:47], s71 offen offset:1024 lds
    buffer_load_dwordx4 v10, s[44:47], s71 offen offset:2048 lds
    buffer_load_dwordx4 v11, s[44:47], s71 offen offset:3072 lds
    s_add_u32 m0, s75, s67
    s_nop 0
    buffer_load_dwordx4 v8, s[44:47], s72 offen offset:0 lds
    buffer_load_dwordx4 v9, s[44:47], s72 offen offset:1024 lds
    buffer_load_dwordx4 v10, s[44:47], s72 offen offset:2048 lds
    buffer_load_dwordx4 v11, s[44:47], s72 offen offset:3072 lds
    s_add_u32 s71, s71, 128
    s_add_u32 s75, s75, 49152
    s_cmp_eq_u32 s75, 147456
    s_cselect_b32 s75, 0, s75
    s_barrier
    s_add_u32 s72, s71, 0x2000
    s_add_u32 m0, s75, s74
    s_nop 0
    buffer_load_dwordx4 v12, s[48:51], s71 offen offset:0 lds
    buffer_load_dwordx4 v13, s[48:51], s71 offen offset:1024 lds
    buffer_load_dwordx4 v14, s[48:51], s71 offen offset:2048 lds
    buffer_load_dwordx4 v15, s[48:51], s71 offen offset:3072 lds
    s_add_u32 m0, s75, s73
    s_nop 0
    s_waitcnt vmcnt(4)
    s_barrier
    buffer_load_dwordx4 v8, s[44:47], s71 offen offset:0 lds
    buffer_load_dwordx4 v9, s[44:47], s71 offen offset:1024 lds
    buffer_load_dwordx4 v10, s[44:47], s71 offen offset:2048 lds
    buffer_load_dwordx4 v11, s[44:47], s71 offen offset:3072 lds
    s_add_u32 m0, s75, s67
    s_nop 0
    buffer_load_dwordx4 v8, s[44:47], s72 offen offset:0 lds
    buffer_load_dwordx4 v9, s[44:47], s72 offen offset:1024 lds
    buffer_load_dwordx4 v10, s[44:47], s72 offen offset:2048 lds
    buffer_load_dwordx4 v11, s[44:47], s72 offen offset:3072 lds
    s_add_u32 s71, s71, 128
    s_add_u32 s75, s75, 49152
    s_cmp_eq_u32 s75, 147456
    s_cselect_b32 s75, 0, s75
    s_add_u32 s72, s71, 0x2000
    s_add_u32 m0, s75, s74
    s_nop 0
    buffer_load_dwordx4 v12, s[48:51], s71 offen offset:0 lds
    buffer_load_dwordx4 v13, s[48:51], s71 offen offset:1024 lds
    buffer_load_dwordx4 v14, s[48:51], s71 offen offset:2048 lds
    buffer_load_dwordx4 v15, s[48:51], s71 offen offset:3072 lds
    s_add_u32 m0, s75, s73
    s_nop 0
    buffer_load_dwordx4 v8, s[44:47], s71 offen offset:0 lds
    buffer_load_dwordx4 v9, s[44:47], s71 offen offset:1024 lds
    buffer_load_dwordx4 v10, s[44:47], s71 offen offset:2048 lds
    buffer_load_dwordx4 v11, s[44:47], s71 offen offset:3072 lds
    s_add_u32 m0, s75, s67
    s_nop 0
    s_waitcnt vmcnt(8)
    s_barrier
    buffer_load_dwordx4 v8, s[44:47], s72 offen offset:0 lds
    buffer_load_dwordx4 v9, s[44:47], s72 offen offset:1024 lds
    buffer_load_dwordx4 v10, s[44:47], s72 offen offset:2048 lds
    buffer_load_dwordx4 v11, s[44:47], s72 offen offset:3072 lds
    s_add_u32 s71, s71, 128
    s_add_u32 s75, s75, 49152
    s_cmp_eq_u32 s75, 147456
    s_cselect_b32 s75, 0, s75
    s_cmp_lt_u32 s81, 2
    s_cbranch_scc1 L_red_10
    v_min_u32 v17, 0, v0
    v_lshlrev_b32 v17, 2, v17
    buffer_load_dword v18, v17, s[60:63], 0 offen sc1
    s_cmp_lg_u32 s81, 2
    s_cbranch_scc1 L_nored_9
    v_lshlrev_b32 v66, 16, v67
    v_lshlrev_b32 v68, 16, v68
    v_lshlrev_b32 v69, 16, v69
    v_mul_f32 v66, 0x3fb8aa3b, v66
    v_exp_f32 v66, v66
    s_nop 0
    v_cvt_pk_bf16_f32 v66, v66, v66
    v_lshlrev_b32 v66, 16, v66
    v_mul_f32 v1, v66, v68
    v_mul_f32 v2, v66, v69
    v_mul_f32 v1, 0x3fb8aa3b, v1
    v_mul_f32 v2, 0.15915494, v2
    v_exp_f32 v1, v1
    v_rndne_f32 v3, v2
    v_sub_f32 v2, v2, v3
    v_cos_f32 v3, v2
    v_sin_f32 v4, v2
    s_nop 0
    v_mul_f32 v64, v1, v3
    v_mul_f32 v65, v1, v4
    v_max_f32 v1, abs(v68), abs(v69)
    v_frexp_exp_i32_f32 v1, v1
    v_sub_u32 v1, 0, v1
    v_ldexp_f32 v68, v68, v1
    v_ldexp_f32 v69, v69, v1
    v_mul_f32 v2, v68, v68
    v_fmac_f32 v2, v69, v69
    v_rcp_f32 v2, v2
    v_add_u32 v1, 1, v1
    v_add_f32 v3, -1.0, v64
    v_mul_f32 v66, v3, v68
    v_fmac_f32 v66, v65, v69
    v_mul_f32 v67, v3, v69
    v_fma_f32 v67, v65, v68, -v67
    v_mul_f32 v66, v66, v2
    v_mul_f32 v67, v67, v2
    v_ldexp_f32 v66, v66, v1
    v_ldexp_f32 v67, v67, v1
    v_mul_f32 v1, v65, v65
    v_mul_f32 v69, v64, v65
    v_fma_f32 v68, v64, v64, -v1
    v_add_f32 v69, v69, v69
    v_mul_f32 v1, v69, v69
    v_mul_f32 v69, v68, v69
    v_fma_f32 v68, v68, v68, -v1
    v_add_f32 v69, v69, v69
    v_mul_f32 v1, v69, v69
    v_mul_f32 v69, v68, v69
    v_fma_f32 v68, v68, v68, -v1
    v_add_f32 v69, v69, v69
    v_mul_f32 v1, v69, v69
    v_mul_f32 v69, v68, v69
    v_fma_f32 v68, v68, v68, -v1
    v_add_f32 v69, v69, v69
    v_mul_f32 v1, v69, v69
    v_mul_f32 v71, v68, v69
    v_fma_f32 v70, v68, v68, -v1
    v_add_f32 v71, v71, v71
    v_mul_f32 v1, v71, v71
    v_mul_f32 v73, v70, v71
    v_fma_f32 v72, v70, v70, -v1
    v_add_f32 v73, v73, v73
    v_mul_f32 v1, v73, v73
    v_mul_f32 v73, v72, v73
    v_fma_f32 v72, v72, v72, -v1
    v_add_f32 v73, v73, v73
    v_mul_f32 v1, v73, v73
    v_mul_f32 v73, v72, v73
    v_fma_f32 v72, v72, v72, -v1
    v_add_f32 v73, v73, v73
    v_and_b32 v1, 15, v0
    v_bfe_u32 v2, v0, 4, 1
    v_lshrrev_b32 v3, 5, v0
    v_lshl_add_u32 v1, v3, 4, v1
    v_lshl_add_u32 v1, v1, 2, v2
    v_lshlrev_b32 v1, 2, v1
    v_add_u32 v74, 147456, v1
    s_branch L_nored_9
L_red_10:
    s_lshl_b32 s77, s81, 11
    s_add_u32 s77, s77, 0x24000
    v_lshl_add_u32 v1, v0, 4, s77
    ds_read_b128 v[64:67], v1 offset:0
    ds_read_b128 v[68:71], v1 offset:1024
    ds_read_b128 v[72:75], v1 offset:4096
    ds_read_b128 v[76:79], v1 offset:5120
    ds_read_b128 v[80:83], v1 offset:8192
    ds_read_b128 v[84:87], v1 offset:9216
    ds_read_b128 v[88:91], v1 offset:12288
    ds_read_b128 v[92:95], v1 offset:13312
    v_lshrrev_b32 v2, 1, v0
    v_xor_b32 v2, v2, v0
    v_and_b32 v2, 4, v2
    v_mul_u32_u24 v2, 3, v2
    v_xor_b32 v2, v2, v0
    v_lshlrev_b32 v2, 4, v2
    s_and_b32 s78, s3, 1
    s_cselect_b32 s80, 1.0, 0x3e8293ee
    s_lshl1_add_u32 s78, s78, s81
    s_lshl2_add_u32 s78, s66, s78
    s_lshl_b32 s79, s78, 10
    s_add_u32 s79, s79, 65536
    s_lshl_b32 s84, s78, 2
    s_waitcnt lgkmcnt(0)
    v_add_f32 v64, v64, v80
    v_add_f32 v65, v65, v81
    v_add_f32 v66, v66, v82
    v_add_f32 v67, v67, v83
    v_add_f32 v68, v68, v84
    v_add_f32 v69, v69, v85
    v_add_f32 v70, v70, v86
    v_add_f32 v71, v71, v87
    v_add_f32 v72, v72, v88
    v_add_f32 v73, v73, v89
    v_add_f32 v74, v74, v90
    v_add_f32 v75, v75, v91
    v_add_f32 v76, v76, v92
    v_add_f32 v77, v77, v93
    v_add_f32 v78, v78, v94
    v_add_f32 v79, v79, v95
    v_add_f32 v64, v64, v72
    v_add_f32 v65, v65, v73
    v_add_f32 v66, v66, v74
    v_add_f32 v67, v67, v75
    v_add_f32 v68, v68, v76
    v_add_f32 v69, v69, v77
    v_add_f32 v70, v70, v78
    v_add_f32 v71, v71, v79
    v_mul_f32 v64, s80, v64
    v_mul_f32 v65, s80, v65
    v_mul_f32 v66, s80, v66
    v_mul_f32 v67, s80, v67
    v_mul_f32 v68, s80, v68
    v_mul_f32 v69, s80, v69
    v_mul_f32 v70, s80, v70
    v_mul_f32 v71, s80, v71
    v_cvt_pk_bf16_f32 v96, v64, v65
    v_cvt_pk_bf16_f32 v97, v66, v67
    v_cvt_pk_bf16_f32 v98, v68, v69
    v_cvt_pk_bf16_f32 v99, v70, v71
    buffer_store_dwordx4 v[96:99], v2, s[40:43], s79 offen sc1
L_nored_9:
    v_min_u32 v17, 0, v0
    v_lshlrev_b32 v17, 2, v17
    buffer_load_dword v18, v17, s[60:63], 0 offen sc1
    s_add_u32 s72, s71, 0x2000
    s_add_u32 m0, s75, s74
    s_nop 0
    buffer_load_dwordx4 v12, s[48:51], s71 offen offset:0 lds
    buffer_load_dwordx4 v13, s[48:51], s71 offen offset:1024 lds
    buffer_load_dwordx4 v14, s[48:51], s71 offen offset:2048 lds
    buffer_load_dwordx4 v15, s[48:51], s71 offen offset:3072 lds
    s_add_u32 m0, s75, s73
    s_nop 0
    s_waitcnt vmcnt(6)
    s_barrier
    buffer_load_dwordx4 v8, s[44:47], s71 offen offset:0 lds
    buffer_load_dwordx4 v9, s[44:47], s71 offen offset:1024 lds
    buffer_load_dwordx4 v10, s[44:47], s71 offen offset:2048 lds
    buffer_load_dwordx4 v11, s[44:47], s71 offen offset:3072 lds
    s_add_u32 m0, s75, s67
    s_nop 0
    buffer_load_dwordx4 v8, s[44:47], s72 offen offset:0 lds
    buffer_load_dwordx4 v9, s[44:47], s72 offen offset:1024 lds
    buffer_load_dwordx4 v10, s[44:47], s72 offen offset:2048 lds
    buffer_load_dwordx4 v11, s[44:47], s72 offen offset:3072 lds
    s_add_u32 s71, s71, 128
    s_add_u32 s75, s75, 49152
    s_cmp_eq_u32 s75, 147456
    s_cselect_b32 s75, 0, s75
    s_cmp_lg_u32 s38, 2
    s_cbranch_scc1 L_sk_11
    ds_write_b32 v74, v64 offset:0
    ds_write_b32 v74, v65 offset:8
    ds_write_b32 v74, v66 offset:512
    ds_write_b32 v74, v67 offset:520
    ds_write_b32 v74, v68 offset:1024
    ds_write_b32 v74, v69 offset:1032
    ds_write_b32 v74, v70 offset:1536
    ds_write_b32 v74, v71 offset:1544
    ds_write_b32 v74, v72 offset:2048
    ds_write_b32 v74, v73 offset:2056
    s_waitcnt lgkmcnt(0)
L_sk_11:
    s_waitcnt vmcnt(12)
    v_cmp_ne_u32 vcc, 1, v18
    s_mov_b64 s[100:101], -1
    s_and_b64 vcc, vcc, s[100:101]
    s_cbranch_scc1 L_spin_12
L_spinr_13:
    s_cmp_ge_u32 s81, 2
    s_cbranch_scc1 L_nkv_14
    v_mov_b32 v1, 1
    s_mov_b64 exec, 1
    buffer_store_dword v1, off, s[40:43], s84 sc1
    s_mov_b64 exec, -1
L_nkv_14:
    s_add_u32 s72, s71, 0x2000
    s_add_u32 m0, s75, s74
    s_nop 0
    buffer_load_dwordx4 v12, s[48:51], s71 offen offset:0 lds
    buffer_load_dwordx4 v13, s[48:51], s71 offen offset:1024 lds
    buffer_load_dwordx4 v14, s[48:51], s71 offen offset:2048 lds
    buffer_load_dwordx4 v15, s[48:51], s71 offen offset:3072 lds
    s_add_u32 m0, s75, s73
    s_nop 0
    buffer_load_dwordx4 v8, s[44:47], s71 offen offset:0 lds
    buffer_load_dwordx4 v9, s[44:47], s71 offen offset:1024 lds
    buffer_load_dwordx4 v10, s[44:47], s71 offen offset:2048 lds
    buffer_load_dwordx4 v11, s[44:47], s71 offen offset:3072 lds
    s_add_u32 m0, s75, s67
    s_nop 0
    s_waitcnt vmcnt(8)
    s_barrier
    buffer_load_dwordx4 v8, s[44:47], s72 offen offset:0 lds
    buffer_load_dwordx4 v9, s[44:47], s72 offen offset:1024 lds
    buffer_load_dwordx4 v10, s[44:47], s72 offen offset:2048 lds
    buffer_load_dwordx4 v11, s[44:47], s72 offen offset:3072 lds
    s_add_u32 s71, s71, 128
    s_add_u32 s75, s75, 49152
    s_cmp_eq_u32 s75, 147456
    s_cselect_b32 s75, 0, s75
    s_add_u32 s72, s71, 0x2000
    s_add_u32 m0, s75, s74
    s_nop 0
    buffer_load_dwordx4 v12, s[48:51], s71 offen offset:0 lds
    buffer_load_dwordx4 v13, s[48:51], s71 offen offset:1024 lds
    buffer_load_dwordx4 v14, s[48:51], s71 offen offset:2048 lds
    buffer_load_dwordx4 v15, s[48:51], s71 offen offset:3072 lds
    s_add_u32 m0, s75, s73
    s_nop 0
    buffer_load_dwordx4 v8, s[44:47], s71 offen offset:0 lds
    buffer_load_dwordx4 v9, s[44:47], s71 offen offset:1024 lds
    buffer_load_dwordx4 v10, s[44:47], s71 offen offset:2048 lds
    buffer_load_dwordx4 v11, s[44:47], s71 offen offset:3072 lds
    s_add_u32 m0, s75, s67
    s_nop 0
    buffer_load_dwordx4 v8, s[44:47], s72 offen offset:0 lds
    buffer_load_dwordx4 v9, s[44:47], s72 offen offset:1024 lds
    buffer_load_dwordx4 v10, s[44:47], s72 offen offset:2048 lds
    buffer_load_dwordx4 v11, s[44:47], s72 offen offset:3072 lds
    s_add_u32 s71, s71, 128
    s_add_u32 s75, s75, 49152
    s_cmp_eq_u32 s75, 147456
    s_cselect_b32 s75, 0, s75
    s_mov_b32 s70, 4
L_lloop_15:
    s_add_u32 s72, s71, 0x2000
    s_add_u32 m0, s75, s74
    s_nop 0
    s_waitcnt vmcnt(12)
    s_barrier
L_lloop_15_r:
    buffer_load_dwordx4 v12, s[48:51], s71 offen offset:0 lds
    buffer_load_dwordx4 v13, s[48:51], s71 offen offset:1024 lds
    buffer_load_dwordx4 v14, s[48:51], s71 offen offset:2048 lds
    buffer_load_dwordx4 v15, s[48:51], s71 offen offset:3072 lds
    s_add_u32 m0, s75, s73
    s_nop 0
    buffer_load_dwordx4 v8, s[44:47], s71 offen offset:0 lds
    buffer_load_dwordx4 v9, s[44:47], s71 offen offset:1024 lds
    buffer_load_dwordx4 v10, s[44:47], s71 offen offset:2048 lds
    buffer_load_dwordx4 v11, s[44:47], s71 offen offset:3072 lds
    s_add_u32 m0, s75, s67
    s_nop 0
    buffer_load_dwordx4 v8, s[44:47], s72 offen offset:0 lds
    buffer_load_dwordx4 v9, s[44:47], s72 offen offset:1024 lds
    buffer_load_dwordx4 v10, s[44:47], s72 offen offset:2048 lds
    buffer_load_dwordx4 v11, s[44:47], s72 offen offset:3072 lds
    s_add_u32 s71, s71, 128
    s_add_u32 s75, s75, 49152
    s_cmp_eq_u32 s75, 147456
    s_cselect_b32 s75, 0, s75
L_lloop0_16:
    s_add_u32 s70, s70, 1
    s_cmp_lg_u32 s70, 14
    s_cbranch_scc1 L_lloop_15
    s_waitcnt lgkmcnt(0)
    v_lshlrev_b32 v37, 4, v0
    v_add_u32 v38, 98304, v37
    v_add_u32 v37, 131072, v37
    v_mov_b32 v39, 0xdddddddd
    v_and_b32 v49, 7, v0
    v_mov_b32 v51, 0x3f803f80
    v_cmp_eq_u32 vcc, 0, v49
    v_cmp_eq_u32 s[100:101], 4, v49
    s_nop 0
    v_cndmask_b32 v48, 0, v51, vcc
    v_cndmask_b32 v50, 0, v51, s[100:101]
    v_mov_b32 v51, v50
    v_mov_b32 v49, v48
    v_mov_b32 v40, 0
    v_mov_b32 v41, 0
    v_mov_b32 v42, 0
    v_mov_b32 v43, 0
    v_mov_b32 v44, 0
    v_mov_b32 v45, 0
    v_mov_b32 v46, 0
    v_mov_b32 v47, 0
    s_lshl_b32 s85, s81, 13
    v_lshl_add_u32 v63, v0, 4, s85
    v_add_u32 v62, 0x1000, v63
    s_lshl3_add_u32 s65, s39, s3
    s_and_b32 s78, s38, 2
    s_lshl3_add_u32 s65, s65, s78
    s_and_b32 s78, s38, 1
    s_lshl2_add_u32 s65, s65, s78
    s_lshl_b32 s65, s65, 10
    s_add_u32 s65, s65, 4210688
    v_and_b32 v1, 15, v0
    v_lshrrev_b32 v2, 5, v0
    v_lshl_add_u32 v1, v2, 4, v1
    v_bfe_u32 v2, v0, 4, 1
    v_lshlrev_b32 v1, 4, v1
    v_lshl_add_u32 v57, v2, 11, v1
    s_lshl3_add_u32 s77, s39, s3
    s_lshl2_add_u32 s64, s77, 1024
    s_lshl2_add_u32 s66, s77, s38
    s_lshl_b32 s66, s66, 12
    s_add_u32 s66, s66, 2097152
    v_lshlrev_b32 v17, 4, v0
    buffer_load_dwordx4 v[28:31], v17, s[40:43], 0 offen sc1
    v_min_u32 v18, 0, v0
    v_lshlrev_b32 v18, 2, v18
    buffer_load_dword v19, v18, s[40:43], s64 offen sc1
    s_waitcnt vmcnt(14)
    s_barrier
    s_waitcnt vmcnt(2)
    s_barrier
    s_waitcnt vmcnt(0)
    v_and_b32 v28, v28, v29
    v_and_b32 v30, v30, v31
    v_and_b32 v28, v28, v30
    v_cmp_ne_u32 vcc, 1, v28
    s_mov_b64 s[100:101], -1
    s_and_b64 vcc, vcc, s[100:101]
    s_cbranch_scc1 L_spin_17
L_spinr_18:
    v_cmp_ne_u32 vcc, 1, v19
    s_mov_b64 s[100:101], -1
    s_and_b64 vcc, vcc, s[100:101]
    s_cbranch_scc1 L_spin_19
L_spinr_20:
    s_mov_b32 s80, 65536
    s_add_u32 m0, s85, 131072
    s_nop 0
    buffer_load_dwordx4 v63, s[40:43], s80 offen offset:0 sc1 lds
    buffer_load_dwordx4 v63, s[40:43], s80 offen offset:1024 sc1 lds
    buffer_load_dwordx4 v63, s[40:43], s80 offen offset:2048 sc1 lds
    buffer_load_dwordx4 v63, s[40:43], s80 offen offset:3072 sc1 lds
    s_add_u32 m0, s85, 135168
    s_nop 0
    buffer_load_dwordx4 v62, s[40:43], s80 offen offset:0 sc1 lds
    buffer_load_dwordx4 v62, s[40:43], s80 offen offset:1024 sc1 lds
    buffer_load_dwordx4 v62, s[40:43], s80 offen offset:2048 sc1 lds
    buffer_load_dwordx4 v62, s[40:43], s80 offen offset:3072 sc1 lds
    v_lshlrev_b32 v8, 4, v0
    buffer_load_dwordx4 v[64:67], v8, s[40:43], s66 offen offset:0 sc1
    buffer_load_dwordx4 v[68:71], v8, s[40:43], s66 offen offset:1024 sc1
    buffer_load_dwordx4 v[72:75], v8, s[40:43], s66 offen offset:2048 sc1
    buffer_load_dwordx4 v[76:79], v8, s[40:43], s66 offen offset:3072 sc1
    s_mov_b32 s48, s30
    s_mov_b32 s49, s31
    s_mov_b32 s50, 0x200000
    s_mov_b32 s51, 0x20000
    s_lshl_b32 s77, s81, 12
    v_lshl_add_u32 v52, v0, 4, s77
    s_lshl_b32 s78, s3, 8
    v_lshrrev_b32 v1, 4, v0
    v_and_b32 v2, 15, v0
    v_lshlrev_b32 v3, 1, v1
    v_xor_b32 v2, v2, v3
    s_lshl_b32 s77, s81, 4
    v_add_lshl_u32 v1, v1, s77, 11
    v_lshl_add_u32 v1, v2, 4, v1
    v_add_u32 v53, s78, v1
    v_xor_b32 v1, 0x80, v53
    v_add_u32 v54, 7168, v53
    v_add_u32 v55, 14336, v1
    v_add_u32 v56, 21504, v1
    s_lshl_b32 s73, s81, 12
    s_add_u32 s74, s73, 16384
    s_mov_b32 s75, 98304
    s_lshl_b32 s82, s3, 0
    s_add_u32 s82, s82, 3
    s_lshl_b32 s82, s82, 1
    s_and_b32 s82, s82, 15
    s_lshl_b32 s86, s39, 18
    s_add_u32 s86, s86, 4194304
    s_waitcnt vmcnt(4)
    s_barrier
    s_setprio 2
    s_lshl_b32 s64, s39, 8
    s_add_u32 s64, s64, 4224
    ds_read_b128 v[80:83], v37 offset:0
    ds_read_b128 v[84:87], v37 offset:1024
    ds_read_b128 v[88:91], v37 offset:4096
    ds_read_b128 v[92:95], v37 offset:5120
    ds_read_b128 v[96:99], v37 offset:2048
    v_mov_b32 v100, 0
    v_mov_b32 v101, 0
    v_mov_b32 v102, 0
    v_mov_b32 v103, 0
    v_mfma_f32_32x32x16_bf16 v[120:135], v[40:43], v[40:43], 0
    v_mfma_f32_32x32x16_bf16 v[152:167], v[40:43], v[40:43], 0
    v_mfma_f32_32x32x16_bf16 v[136:151], v[40:43], v[40:43], 0
    s_mov_b32 s70, 0
    s_mov_b32 s84, 98304
    s_waitcnt vmcnt(0)
    s_waitcnt lgkmcnt(3)
    v_mfma_f32_32x32x16_bf16 v[104:119], v[80:83], v[64:67], 0
    v_mfma_f32_32x32x16_bf16 v[104:119], v[84:87], v[68:71], v[104:119]
    s_nop 11
    s_setprio 0
    s_barrier
    .p2align 3
L_att_21:
    v_exp_f32 v104, v104
    v_exp_f32 v105, v105
    v_smfmac_f32_32x32x32_bf16 v[152:167], v[100:103], v[128:135], v39
    v_exp_f32 v106, v106
    v_exp_f32 v107, v107
    v_exp_f32 v108, v108
    v_smfmac_f32_16x16x64_bf16 v[44:47], v[48:51], v[128:135], v39
    ds_read_b128 v[100:103], v37 offset:3072
    v_exp_f32 v109, v109
    v_mfma_f32_32x32x16_bf16 v[120:135], v[80:83], v[72:75], 0
    v_exp_f32 v110, v110
    v_exp_f32 v111, v111
    v_exp_f32 v112, v112
    v_mfma_f32_32x32x16_bf16 v[120:135], v[84:87], v[76:79], v[120:135]
    s_waitcnt lgkmcnt(1)
    v_exp_f32 v113, v113
    v_exp_f32 v114, v114
    v_exp_f32 v115, v115
    v_exp_f32 v116, v116
    v_smfmac_f32_32x32x32_bf16 v[136:151], v[96:99], v[104:111], v39
    s_waitcnt lgkmcnt(0)
    v_exp_f32 v117, v117
    v_exp_f32 v118, v118
    v_exp_f32 v119, v119
    v_smfmac_f32_16x16x64_bf16 v[40:43], v[48:51], v[104:111], v39
    ds_read_b128 v[80:83], v37 offset:8192
    v_exp_f32 v120, v120
    v_exp_f32 v121, v121
    v_smfmac_f32_32x32x32_bf16 v[136:151], v[100:103], v[112:119], v39
    v_exp_f32 v122, v122
    v_exp_f32 v123, v123
    v_exp_f32 v124, v124
    v_smfmac_f32_16x16x64_bf16 v[40:43], v[48:51], v[112:119], v39
    ds_read_b128 v[84:87], v37 offset:9216
    v_exp_f32 v125, v125
    v_mfma_f32_32x32x16_bf16 v[104:119], v[88:91], v[64:67], 0
    v_exp_f32 v126, v126
    v_exp_f32 v127, v127
    v_exp_f32 v128, v128
    v_mfma_f32_32x32x16_bf16 v[104:119], v[92:95], v[68:71], v[104:119]
    s_nop 0
    v_exp_f32 v129, v129
    v_exp_f32 v130, v130
    v_exp_f32 v131, v131
    v_exp_f32 v132, v132
    v_smfmac_f32_32x32x32_bf16 v[152:167], v[96:99], v[120:127], v39
    s_nop 0
    v_exp_f32 v133, v133
    v_exp_f32 v134, v134
    v_exp_f32 v135, v135
    v_smfmac_f32_16x16x64_bf16 v[44:47], v[48:51], v[120:127], v39
    ds_read_b128 v[96:99], v37 offset:6144
    v_exp_f32 v104, v104
    v_exp_f32 v105, v105
    v_smfmac_f32_32x32x32_bf16 v[152:167], v[100:103], v[128:135], v39
    v_exp_f32 v106, v106
    v_exp_f32 v107, v107
    v_exp_f32 v108, v108
    v_smfmac_f32_16x16x64_bf16 v[44:47], v[48:51], v[128:135], v39
    ds_read_b128 v[100:103], v37 offset:7168
    v_exp_f32 v109, v109
    v_mfma_f32_32x32x16_bf16 v[120:135], v[88:91], v[72:75], 0
    v_exp_f32 v110, v110
    v_exp_f32 v111, v111
    v_exp_f32 v112, v112
    v_mfma_f32_32x32x16_bf16 v[120:135], v[92:95], v[76:79], v[120:135]
    s_waitcnt lgkmcnt(1)
    v_exp_f32 v113, v113
    v_exp_f32 v114, v114
    v_exp_f32 v115, v115
    v_exp_f32 v116, v116
    v_smfmac_f32_32x32x32_bf16 v[136:151], v[96:99], v[104:111], v39
    s_waitcnt lgkmcnt(0)
    v_exp_f32 v117, v117
    v_exp_f32 v118, v118
    v_exp_f32 v119, v119
    v_smfmac_f32_16x16x64_bf16 v[40:43], v[48:51], v[104:111], v39
    ds_read_b128 v[88:91], v37 offset:12288
    v_exp_f32 v120, v120
    v_exp_f32 v121, v121
    v_smfmac_f32_32x32x32_bf16 v[136:151], v[100:103], v[112:119], v39
    v_exp_f32 v122, v122
    v_exp_f32 v123, v123
    v_exp_f32 v124, v124
    v_smfmac_f32_16x16x64_bf16 v[40:43], v[48:51], v[112:119], v39
    ds_read_b128 v[92:95], v37 offset:13312
    v_exp_f32 v125, v125
    v_mfma_f32_32x32x16_bf16 v[104:119], v[80:83], v[64:67], 0
    v_exp_f32 v126, v126
    v_exp_f32 v127, v127
    v_exp_f32 v128, v128
    v_mfma_f32_32x32x16_bf16 v[104:119], v[84:87], v[68:71], v[104:119]
    s_nop 0
    v_exp_f32 v129, v129
    v_exp_f32 v130, v130
    v_exp_f32 v131, v131
    v_exp_f32 v132, v132
    v_smfmac_f32_32x32x32_bf16 v[152:167], v[96:99], v[120:127], v39
    s_nop 0
    v_exp_f32 v133, v133
    v_exp_f32 v134, v134
    v_exp_f32 v135, v135
    v_smfmac_f32_16x16x64_bf16 v[44:47], v[48:51], v[120:127], v39
    ds_read_b128 v[96:99], v37 offset:10240
    v_exp_f32 v104, v104
    v_exp_f32 v105, v105
    v_smfmac_f32_32x32x32_bf16 v[152:167], v[100:103], v[128:135], v39
    v_exp_f32 v106, v106
    v_exp_f32 v107, v107
    v_exp_f32 v108, v108
    v_smfmac_f32_16x16x64_bf16 v[44:47], v[48:51], v[128:135], v39
    ds_read_b128 v[100:103], v37 offset:11264
    v_exp_f32 v109, v109
    v_mfma_f32_32x32x16_bf16 v[120:135], v[80:83], v[72:75], 0
    v_exp_f32 v110, v110
    v_exp_f32 v111, v111
    v_exp_f32 v112, v112
    v_mfma_f32_32x32x16_bf16 v[120:135], v[84:87], v[76:79], v[120:135]
    s_waitcnt lgkmcnt(1)
    v_exp_f32 v113, v113
    v_exp_f32 v114, v114
    v_exp_f32 v115, v115
    v_exp_f32 v116, v116
    v_smfmac_f32_32x32x32_bf16 v[136:151], v[96:99], v[104:111], v39
    s_waitcnt lgkmcnt(0)
    v_exp_f32 v117, v117
    v_exp_f32 v118, v118
    v_exp_f32 v119, v119
    v_smfmac_f32_16x16x64_bf16 v[40:43], v[48:51], v[104:111], v39
    ds_read_b128 v[80:83], v37 offset:16384
    v_exp_f32 v120, v120
    v_exp_f32 v121, v121
    v_smfmac_f32_32x32x32_bf16 v[136:151], v[100:103], v[112:119], v39
    v_exp_f32 v122, v122
    v_exp_f32 v123, v123
    v_exp_f32 v124, v124
    v_smfmac_f32_16x16x64_bf16 v[40:43], v[48:51], v[112:119], v39
    ds_read_b128 v[84:87], v37 offset:17408
    v_exp_f32 v125, v125
    v_mfma_f32_32x32x16_bf16 v[104:119], v[88:91], v[64:67], 0
    v_exp_f32 v126, v126
    v_exp_f32 v127, v127
    v_exp_f32 v128, v128
    v_mfma_f32_32x32x16_bf16 v[104:119], v[92:95], v[68:71], v[104:119]
    s_nop 0
    v_exp_f32 v129, v129
    v_exp_f32 v130, v130
    v_exp_f32 v131, v131
    v_exp_f32 v132, v132
    v_smfmac_f32_32x32x32_bf16 v[152:167], v[96:99], v[120:127], v39
    s_nop 0
    v_exp_f32 v133, v133
    v_exp_f32 v134, v134
    v_exp_f32 v135, v135
    v_smfmac_f32_16x16x64_bf16 v[44:47], v[48:51], v[120:127], v39
    ds_read_b128 v[96:99], v37 offset:14336
    v_exp_f32 v104, v104
    v_exp_f32 v105, v105
    v_smfmac_f32_32x32x32_bf16 v[152:167], v[100:103], v[128:135], v39
    v_exp_f32 v106, v106
    v_exp_f32 v107, v107
    v_exp_f32 v108, v108
    v_smfmac_f32_16x16x64_bf16 v[44:47], v[48:51], v[128:135], v39
    ds_read_b128 v[100:103], v37 offset:15360
    v_exp_f32 v109, v109
    v_mfma_f32_32x32x16_bf16 v[120:135], v[88:91], v[72:75], 0
    v_exp_f32 v110, v110
    v_exp_f32 v111, v111
    v_exp_f32 v112, v112
    v_mfma_f32_32x32x16_bf16 v[120:135], v[92:95], v[76:79], v[120:135]
    s_waitcnt lgkmcnt(1)
    v_exp_f32 v113, v113
    v_exp_f32 v114, v114
    v_exp_f32 v115, v115
    v_exp_f32 v116, v116
    v_smfmac_f32_32x32x32_bf16 v[136:151], v[96:99], v[104:111], v39
    s_waitcnt lgkmcnt(0)
    v_exp_f32 v117, v117
    v_exp_f32 v118, v118
    v_exp_f32 v119, v119
    v_smfmac_f32_16x16x64_bf16 v[40:43], v[48:51], v[104:111], v39
    ds_read_b128 v[88:91], v37 offset:20480
    v_exp_f32 v120, v120
    v_exp_f32 v121, v121
    v_smfmac_f32_32x32x32_bf16 v[136:151], v[100:103], v[112:119], v39
    s_sub_u32 s84, s84, 0x8000
    v_exp_f32 v122, v122
    v_exp_f32 v123, v123
    v_exp_f32 v124, v124
    v_smfmac_f32_16x16x64_bf16 v[40:43], v[48:51], v[112:119], v39
    ds_read_b128 v[92:95], v37 offset:21504
    v_exp_f32 v125, v125
    v_mfma_f32_32x32x16_bf16 v[104:119], v[80:83], v[64:67], 0
    s_cmp_lt_u32 s84, 65536
    v_exp_f32 v126, v126
    v_exp_f32 v127, v127
    v_exp_f32 v128, v128
    v_mfma_f32_32x32x16_bf16 v[104:119], v[84:87], v[68:71], v[104:119]
    s_cselect_b32 s84, 131072, s84
    v_exp_f32 v129, v129
    v_exp_f32 v130, v130
    v_exp_f32 v131, v131
    v_exp_f32 v132, v132
    v_smfmac_f32_32x32x32_bf16 v[152:167], v[96:99], v[120:127], v39
    s_nop 0
    v_exp_f32 v133, v133
    v_exp_f32 v134, v134
    v_exp_f32 v135, v135
    v_smfmac_f32_16x16x64_bf16 v[44:47], v[48:51], v[120:127], v39
    ds_read_b128 v[96:99], v37 offset:18432
    v_exp_f32 v104, v104
    v_exp_f32 v105, v105
    v_smfmac_f32_32x32x32_bf16 v[152:167], v[100:103], v[128:135], v39
    v_exp_f32 v106, v106
    v_exp_f32 v107, v107
    v_exp_f32 v108, v108
    v_smfmac_f32_16x16x64_bf16 v[44:47], v[48:51], v[128:135], v39
    ds_read_b128 v[100:103], v37 offset:19456
    v_exp_f32 v109, v109
    v_mfma_f32_32x32x16_bf16 v[120:135], v[80:83], v[72:75], 0
    v_exp_f32 v110, v110
    v_exp_f32 v111, v111
    v_exp_f32 v112, v112
    v_mfma_f32_32x32x16_bf16 v[120:135], v[84:87], v[76:79], v[120:135]
    s_waitcnt lgkmcnt(1)
    v_exp_f32 v113, v113
    v_exp_f32 v114, v114
    v_exp_f32 v115, v115
    v_exp_f32 v116, v116
    v_smfmac_f32_32x32x32_bf16 v[136:151], v[96:99], v[104:111], v39
    s_waitcnt lgkmcnt(0)
    v_exp_f32 v117, v117
    v_exp_f32 v118, v118
    v_exp_f32 v119, v119
    v_smfmac_f32_16x16x64_bf16 v[40:43], v[48:51], v[104:111], v39
    ds_read_b128 v[80:83], v37 offset:24576
    v_exp_f32 v120, v120
    v_exp_f32 v121, v121
    v_smfmac_f32_32x32x32_bf16 v[136:151], v[100:103], v[112:119], v39
    v_exp_f32 v122, v122
    v_exp_f32 v123, v123
    v_exp_f32 v124, v124
    v_smfmac_f32_16x16x64_bf16 v[40:43], v[48:51], v[112:119], v39
    ds_read_b128 v[84:87], v37 offset:25600
    v_exp_f32 v125, v125
    v_mfma_f32_32x32x16_bf16 v[104:119], v[88:91], v[64:67], 0
    v_exp_f32 v126, v126
    v_exp_f32 v127, v127
    v_exp_f32 v128, v128
    v_mfma_f32_32x32x16_bf16 v[104:119], v[92:95], v[68:71], v[104:119]
    s_nop 0
    v_exp_f32 v129, v129
    v_exp_f32 v130, v130
    v_exp_f32 v131, v131
    v_exp_f32 v132, v132
    v_smfmac_f32_32x32x32_bf16 v[152:167], v[96:99], v[120:127], v39
    s_nop 0
    v_exp_f32 v133, v133
    v_exp_f32 v134, v134
    v_exp_f32 v135, v135
    v_smfmac_f32_16x16x64_bf16 v[44:47], v[48:51], v[120:127], v39
    ds_read_b128 v[96:99], v37 offset:22528
    v_exp_f32 v104, v104
    v_exp_f32 v105, v105
    v_smfmac_f32_32x32x32_bf16 v[152:167], v[100:103], v[128:135], v39
    v_exp_f32 v106, v106
    v_exp_f32 v107, v107
    v_exp_f32 v108, v108
    v_smfmac_f32_16x16x64_bf16 v[44:47], v[48:51], v[128:135], v39
    ds_read_b128 v[100:103], v37 offset:23552
    v_exp_f32 v109, v109
    v_mfma_f32_32x32x16_bf16 v[120:135], v[88:91], v[72:75], 0
    v_exp_f32 v110, v110
    v_exp_f32 v111, v111
    v_exp_f32 v112, v112
    v_mfma_f32_32x32x16_bf16 v[120:135], v[92:95], v[76:79], v[120:135]
    s_waitcnt lgkmcnt(1)
    v_exp_f32 v113, v113
    v_exp_f32 v114, v114
    v_exp_f32 v115, v115
    v_exp_f32 v116, v116
    v_smfmac_f32_32x32x32_bf16 v[136:151], v[96:99], v[104:111], v39
    s_waitcnt lgkmcnt(0)
    v_exp_f32 v117, v117
    v_exp_f32 v118, v118
    v_exp_f32 v119, v119
    v_smfmac_f32_16x16x64_bf16 v[40:43], v[48:51], v[104:111], v39
    ds_read_b128 v[88:91], v37 offset:28672
    v_exp_f32 v120, v120
    v_exp_f32 v121, v121
    v_smfmac_f32_32x32x32_bf16 v[136:151], v[100:103], v[112:119], v39
    v_exp_f32 v122, v122
    v_exp_f32 v123, v123
    v_exp_f32 v124, v124
    v_smfmac_f32_16x16x64_bf16 v[40:43], v[48:51], v[112:119], v39
    ds_read_b128 v[92:95], v37 offset:29696
    v_exp_f32 v125, v125
    v_mfma_f32_32x32x16_bf16 v[104:119], v[80:83], v[64:67], 0
    v_exp_f32 v126, v126
    v_exp_f32 v127, v127
    v_exp_f32 v128, v128
    v_mfma_f32_32x32x16_bf16 v[104:119], v[84:87], v[68:71], v[104:119]
    s_nop 0
    v_exp_f32 v129, v129
    v_exp_f32 v130, v130
    v_exp_f32 v131, v131
    v_exp_f32 v132, v132
    v_smfmac_f32_32x32x32_bf16 v[152:167], v[96:99], v[120:127], v39
    s_nop 0
    v_exp_f32 v133, v133
    v_exp_f32 v134, v134
    v_exp_f32 v135, v135
    v_smfmac_f32_16x16x64_bf16 v[44:47], v[48:51], v[120:127], v39
    ds_read_b128 v[96:99], v37 offset:26624
    v_exp_f32 v104, v104
    v_exp_f32 v105, v105
    v_smfmac_f32_32x32x32_bf16 v[152:167], v[100:103], v[128:135], v39
    v_exp_f32 v106, v106
    v_exp_f32 v107, v107
    v_exp_f32 v108, v108
    v_smfmac_f32_16x16x64_bf16 v[44:47], v[48:51], v[128:135], v39
    ds_read_b128 v[100:103], v37 offset:27648
    v_exp_f32 v109, v109
    v_mfma_f32_32x32x16_bf16 v[120:135], v[80:83], v[72:75], 0
    v_exp_f32 v110, v110
    v_exp_f32 v111, v111
    v_exp_f32 v112, v112
    v_mfma_f32_32x32x16_bf16 v[120:135], v[84:87], v[76:79], v[120:135]
    s_waitcnt lgkmcnt(1)
    v_exp_f32 v113, v113
    v_exp_f32 v114, v114
    v_exp_f32 v115, v115
    v_exp_f32 v116, v116
    v_smfmac_f32_32x32x32_bf16 v[136:151], v[96:99], v[104:111], v39
    s_waitcnt vmcnt(0) lgkmcnt(0)
    s_barrier
    v_exp_f32 v117, v117
    v_exp_f32 v118, v118
    v_exp_f32 v119, v119
    v_smfmac_f32_16x16x64_bf16 v[40:43], v[48:51], v[104:111], v39
    ds_read_b128 v[80:83], v38 offset:0
    v_exp_f32 v120, v120
    v_exp_f32 v121, v121
    v_smfmac_f32_32x32x32_bf16 v[136:151], v[100:103], v[112:119], v39
    v_exp_f32 v122, v122
    v_exp_f32 v123, v123
    v_exp_f32 v124, v124
    v_smfmac_f32_16x16x64_bf16 v[40:43], v[48:51], v[112:119], v39
    ds_read_b128 v[84:87], v38 offset:1024
    v_exp_f32 v125, v125
    v_mfma_f32_32x32x16_bf16 v[104:119], v[88:91], v[64:67], 0
    v_exp_f32 v126, v126
    v_exp_f32 v127, v127
    v_exp_f32 v128, v128
    v_mfma_f32_32x32x16_bf16 v[104:119], v[92:95], v[68:71], v[104:119]
    s_nop 0
    v_exp_f32 v129, v129
    v_exp_f32 v130, v130
    v_exp_f32 v131, v131
    v_exp_f32 v132, v132
    v_smfmac_f32_32x32x32_bf16 v[152:167], v[96:99], v[120:127], v39
    s_nop 0
    v_exp_f32 v133, v133
    v_exp_f32 v134, v134
    v_exp_f32 v135, v135
    v_smfmac_f32_16x16x64_bf16 v[44:47], v[48:51], v[120:127], v39
    ds_read_b128 v[96:99], v37 offset:30720
    v_exp_f32 v104, v104
    v_exp_f32 v105, v105
    v_smfmac_f32_32x32x32_bf16 v[152:167], v[100:103], v[128:135], v39
    v_exp_f32 v106, v106
    v_exp_f32 v107, v107
    v_exp_f32 v108, v108
    v_smfmac_f32_16x16x64_bf16 v[44:47], v[48:51], v[128:135], v39
    ds_read_b128 v[100:103], v37 offset:31744
    v_exp_f32 v109, v109
    v_mfma_f32_32x32x16_bf16 v[120:135], v[88:91], v[72:75], 0
    v_mov_b32 v37, v38
    v_lshl_add_u32 v38, v0, 4, s84
    v_exp_f32 v110, v110
    v_exp_f32 v111, v111
    v_exp_f32 v112, v112
    v_mfma_f32_32x32x16_bf16 v[120:135], v[92:95], v[76:79], v[120:135]
    s_waitcnt lgkmcnt(1)
    v_exp_f32 v113, v113
    v_exp_f32 v114, v114
    v_exp_f32 v115, v115
    v_exp_f32 v116, v116
    v_smfmac_f32_32x32x32_bf16 v[136:151], v[96:99], v[104:111], v39
    s_waitcnt lgkmcnt(0)
    v_exp_f32 v117, v117
    v_exp_f32 v118, v118
    v_exp_f32 v119, v119
    v_smfmac_f32_16x16x64_bf16 v[40:43], v[48:51], v[104:111], v39
    ds_read_b128 v[88:91], v37 offset:4096
    v_exp_f32 v120, v120
    v_exp_f32 v121, v121
    v_smfmac_f32_32x32x32_bf16 v[136:151], v[100:103], v[112:119], v39
    v_exp_f32 v122, v122
    v_exp_f32 v123, v123
    v_exp_f32 v124, v124
    v_smfmac_f32_16x16x64_bf16 v[40:43], v[48:51], v[112:119], v39
    ds_read_b128 v[92:95], v37 offset:5120
    v_exp_f32 v125, v125
    v_mfma_f32_32x32x16_bf16 v[104:119], v[80:83], v[64:67], 0
    s_add_u32 s70, s70, 1
    v_exp_f32 v126, v126
    v_exp_f32 v127, v127
    v_exp_f32 v128, v128
    v_mfma_f32_32x32x16_bf16 v[104:119], v[84:87], v[68:71], v[104:119]
    s_cmp_lt_u32 s70, 8
    v_exp_f32 v129, v129
    v_exp_f32 v130, v130
    v_exp_f32 v131, v131
    v_exp_f32 v132, v132
    v_smfmac_f32_32x32x32_bf16 v[152:167], v[96:99], v[120:127], v39
    s_nop 0
    v_exp_f32 v133, v133
    v_exp_f32 v134, v134
    v_exp_f32 v135, v135
    v_smfmac_f32_16x16x64_bf16 v[44:47], v[48:51], v[120:127], v39
    ds_read_b128 v[96:99], v37 offset:2048
    s_cbranch_scc1 L_att_21
    v_smfmac_f32_32x32x32_bf16 v[152:167], v[100:103], v[128:135], v39
    v_smfmac_f32_16x16x64_bf16 v[44:47], v[48:51], v[128:135], v39
    s_waitcnt lgkmcnt(0)
    s_mov_b32 s79, 0x2b800000
    s_barrier
    s_lshl_b32 s72, s82, 17
    s_lshl_b32 s71, s82, 14
    s_add_u32 s71, s71, s86
    s_add_u32 m0, s75, s73
    s_nop 0
    buffer_load_dwordx4 v53, s[48:51], s72 offen offset:0 lds
    v_fma_f32 v4, 0, v136, v40
    v_fmac_f32 v4, 0, v137
    v_fmac_f32 v4, 0, v138
    v_fmac_f32 v4, 0, v139
    v_fmac_f32 v4, 0, v140
    v_fmac_f32 v4, 0, v141
    buffer_load_dwordx4 v54, s[48:51], s72 offen offset:1024 lds
    v_fmac_f32 v4, 0, v142
    v_fmac_f32 v4, 0, v143
    v_fmac_f32 v4, 0, v144
    v_fmac_f32 v4, 0, v145
    v_fmac_f32 v4, 0, v146
    buffer_load_dwordx4 v55, s[48:51], s72 offen offset:2048 lds
    v_fmac_f32 v4, 0, v147
    v_fmac_f32 v4, 0, v148
    v_fmac_f32 v4, 0, v149
    v_fmac_f32 v4, 0, v150
    v_fmac_f32 v4, 0, v151
    v_cmp_ngt_f32 vcc, 0x76800000, v4
    v_cmp_nle_f32 s[100:101], s79, v4
    buffer_load_dwordx4 v56, s[48:51], s72 offen offset:3072 lds
    s_nop 0
    s_or_b64 vcc, vcc, s[100:101]
    s_cbranch_scc1 L_slow_22
L_slowr_23:
    v_rcp_f32 v4, v40
    s_add_u32 m0, s75, s74
    s_nop 0
    buffer_load_dwordx4 v52, s[40:43], s71 offen offset:0 sc1 lds
    v_mul_f32 v136, v136, v4
    v_mul_f32 v137, v137, v4
    v_mul_f32 v138, v138, v4
    v_mul_f32 v139, v139, v4
    v_mul_f32 v140, v140, v4
    v_mul_f32 v141, v141, v4
    buffer_load_dwordx4 v52, s[40:43], s71 offen offset:1024 sc1 lds
    v_mul_f32 v142, v142, v4
    v_mul_f32 v143, v143, v4
    v_mul_f32 v144, v144, v4
    v_mul_f32 v145, v145, v4
    v_mul_f32 v146, v146, v4
    v_mul_f32 v147, v147, v4
    buffer_load_dwordx4 v52, s[40:43], s71 offen offset:2048 sc1 lds
    v_mul_f32 v148, v148, v4
    v_mul_f32 v149, v149, v4
    v_mul_f32 v150, v150, v4
    v_mul_f32 v151, v151, v4
    v_cvt_pk_bf16_f32 v168, v136, v137
    v_cvt_pk_bf16_f32 v169, v138, v139
    v_cvt_pk_bf16_f32 v170, v140, v141
    v_cvt_pk_bf16_f32 v171, v142, v143
    v_cvt_pk_bf16_f32 v172, v144, v145
    v_cvt_pk_bf16_f32 v173, v146, v147
    v_cvt_pk_bf16_f32 v174, v148, v149
    v_cvt_pk_bf16_f32 v175, v150, v151
    buffer_store_dwordx4 v[168:171], v57, s[40:43], s65 offen offset:0 sc1
    buffer_store_dwordx4 v[172:175], v57, s[40:43], s65 offen offset:512 sc1
    s_add_u32 s65, s65, 0x1000
    buffer_load_dwordx4 v52, s[40:43], s71 offen offset:3072 sc1 lds
    s_add_u32 s82, s82, 2
    s_and_b32 s82, s82, 15
    s_add_u32 s75, s75, 0x8000
    s_and_b32 s75, s75, 0x1ffff
    s_barrier
    s_lshl_b32 s72, s82, 17
    s_lshl_b32 s71, s82, 14
    s_add_u32 s71, s71, s86
    s_add_u32 m0, s75, s73
    s_nop 0
    buffer_load_dwordx4 v53, s[48:51], s72 offen offset:0 lds
    v_fma_f32 v4, 0, v152, v44
    v_fmac_f32 v4, 0, v153
    v_fmac_f32 v4, 0, v154
    v_fmac_f32 v4, 0, v155
    v_fmac_f32 v4, 0, v156
    v_fmac_f32 v4, 0, v157
    buffer_load_dwordx4 v54, s[48:51], s72 offen offset:1024 lds
    v_fmac_f32 v4, 0, v158
    v_fmac_f32 v4, 0, v159
    v_fmac_f32 v4, 0, v160
    v_fmac_f32 v4, 0, v161
    v_fmac_f32 v4, 0, v162
    buffer_load_dwordx4 v55, s[48:51], s72 offen offset:2048 lds
    v_fmac_f32 v4, 0, v163
    v_fmac_f32 v4, 0, v164
    v_fmac_f32 v4, 0, v165
    v_fmac_f32 v4, 0, v166
    v_fmac_f32 v4, 0, v167
    v_cmp_ngt_f32 vcc, 0x76800000, v4
    v_cmp_nle_f32 s[100:101], s79, v4
    buffer_load_dwordx4 v56, s[48:51], s72 offen offset:3072 lds
    s_nop 0
    s_or_b64 vcc, vcc, s[100:101]
    s_cbranch_scc1 L_slow_24
L_slowr_25:
    v_rcp_f32 v4, v44
    s_add_u32 m0, s75, s74
    s_nop 0
    buffer_load_dwordx4 v52, s[40:43], s71 offen offset:0 sc1 lds
    v_mul_f32 v152, v152, v4
    v_mul_f32 v153, v153, v4
    v_mul_f32 v154, v154, v4
    v_mul_f32 v155, v155, v4
    v_mul_f32 v156, v156, v4
    v_mul_f32 v157, v157, v4
    buffer_load_dwordx4 v52, s[40:43], s71 offen offset:1024 sc1 lds
    v_mul_f32 v158, v158, v4
    v_mul_f32 v159, v159, v4
    v_mul_f32 v160, v160, v4
    v_mul_f32 v161, v161, v4
    v_mul_f32 v162, v162, v4
    v_mul_f32 v163, v163, v4
    buffer_load_dwordx4 v52, s[40:43], s71 offen offset:2048 sc1 lds
    v_mul_f32 v164, v164, v4
    v_mul_f32 v165, v165, v4
    v_mul_f32 v166, v166, v4
    v_mul_f32 v167, v167, v4
    v_cvt_pk_bf16_f32 v176, v152, v153
    v_cvt_pk_bf16_f32 v177, v154, v155
    v_cvt_pk_bf16_f32 v178, v156, v157
    v_cvt_pk_bf16_f32 v179, v158, v159
    v_cvt_pk_bf16_f32 v180, v160, v161
    v_cvt_pk_bf16_f32 v181, v162, v163
    v_cvt_pk_bf16_f32 v182, v164, v165
    v_cvt_pk_bf16_f32 v183, v166, v167
    buffer_store_dwordx4 v[176:179], v57, s[40:43], s65 offen offset:0 sc1
    buffer_store_dwordx4 v[180:183], v57, s[40:43], s65 offen offset:512 sc1
    s_add_u32 s65, s65, 0x1000
    buffer_load_dwordx4 v52, s[40:43], s71 offen offset:3072 sc1 lds
    s_add_u32 s82, s82, 2
    s_and_b32 s82, s82, 15
    s_add_u32 s75, s75, 0x8000
    s_and_b32 s75, s75, 0x1ffff
    s_mov_b32 s70, 3
L_lloop_26:
    s_lshl_b32 s72, s82, 17
    s_lshl_b32 s71, s82, 14
    s_add_u32 s71, s71, s86
    s_add_u32 m0, s75, s73
    s_nop 0
    buffer_load_dwordx4 v53, s[48:51], s72 offen offset:0 lds
    buffer_load_dwordx4 v54, s[48:51], s72 offen offset:1024 lds
    s_waitcnt vmcnt(10)
    s_barrier
L_lloop_26_r:
    buffer_load_dwordx4 v55, s[48:51], s72 offen offset:2048 lds
    buffer_load_dwordx4 v56, s[48:51], s72 offen offset:3072 lds
    s_add_u32 m0, s75, s74
    s_nop 0
    buffer_load_dwordx4 v52, s[40:43], s71 offen offset:0 sc1 lds
    buffer_load_dwordx4 v52, s[40:43], s71 offen offset:1024 sc1 lds
    buffer_load_dwordx4 v52, s[40:43], s71 offen offset:2048 sc1 lds
    buffer_load_dwordx4 v52, s[40:43], s71 offen offset:3072 sc1 lds
    s_add_u32 s82, s82, 2
    s_and_b32 s82, s82, 15
    s_add_u32 s75, s75, 0x8000
    s_and_b32 s75, s75, 0x1ffff
L_lloop0_27:
    s_bitcmp1_b32 104, s70
    s_cbranch_scc1 L_hk_28
L_hkr_29:
    s_add_u32 s70, s70, 1
    s_cmp_lg_u32 s70, 14
    s_cbranch_scc1 L_lloop_26
    s_waitcnt vmcnt(8)
    s_barrier
    s_waitcnt vmcnt(0)
    s_barrier
    s_branch L_g1end_3
L_spin_12:
    s_mov_b32 s76, 400000
L_sp_30:
    s_sleep 1
    buffer_load_dword v18, v17, s[60:63], 0 offen sc1
    s_waitcnt vmcnt(0)
    v_cmp_ne_u32 vcc, 1, v18
    s_mov_b64 s[100:101], -1
    s_and_b64 vcc, vcc, s[100:101]
    s_cbranch_scc0 L_spinr_13
    s_sub_u32 s76, s76, 1
    s_cmp_lg_u32 s76, 0
    s_cbranch_scc1 L_sp_30
    s_branch L_spinr_13
L_spin_17:
    s_mov_b32 s76, 400000
L_sp_31:
    s_sleep 1
    buffer_load_dwordx4 v[28:31], v17, s[40:43], 0 offen sc1
    s_waitcnt vmcnt(0)
    v_and_b32 v28, v28, v29
    v_and_b32 v30, v30, v31
    v_and_b32 v28, v28, v30
    v_cmp_ne_u32 vcc, 1, v28
    s_mov_b64 s[100:101], -1
    s_and_b64 vcc, vcc, s[100:101]
    s_cbranch_scc0 L_spinr_18
    s_sub_u32 s76, s76, 1
    s_cmp_lg_u32 s76, 0
    s_cbranch_scc1 L_sp_31
    s_branch L_spinr_18
L_spin_19:
    s_mov_b32 s76, 400000
L_sp_32:
    s_sleep 1
    buffer_load_dword v19, v18, s[40:43], s64 offen sc1
    s_waitcnt vmcnt(0)
    v_cmp_ne_u32 vcc, 1, v19
    s_mov_b64 s[100:101], -1
    s_and_b64 vcc, vcc, s[100:101]
    s_cbranch_scc0 L_spinr_20
    s_sub_u32 s76, s76, 1
    s_cmp_lg_u32 s76, 0
    s_cbranch_scc1 L_sp_32
    s_branch L_spinr_20
L_slow_22:
    v_lshlrev_b32 v1, 4, v0
    v_mov_b32 v2, 0xff800000
    s_mov_b32 s77, 65536
L_slow1_33:
    buffer_load_dwordx4 v[80:83], v1, s[40:43], s77 offen sc1
    buffer_load_dwordx4 v[84:87], v1, s[40:43], s77 offen offset:1024 sc1
    s_waitcnt vmcnt(0)
    v_mfma_f32_32x32x16_bf16 v[104:119], v[80:83], v[64:67], 0
    v_mfma_f32_32x32x16_bf16 v[104:119], v[84:87], v[68:71], v[104:119]
    s_nop 15
    v_max3_f32 v2, v2, v104, v105
    v_max3_f32 v2, v2, v106, v107
    v_max3_f32 v2, v2, v108, v109
    v_max3_f32 v2, v2, v110, v111
    v_max3_f32 v2, v2, v112, v113
    v_max3_f32 v2, v2, v114, v115
    v_max3_f32 v2, v2, v116, v117
    v_max3_f32 v2, v2, v118, v119
    s_add_u32 s77, s77, 4096
    s_cmp_lt_u32 s77, 327680
    s_cbranch_scc1 L_slow1_33
    v_mov_b32 v120, v2
    s_nop 1
    v_permlane32_swap_b32 v120, v2
    s_nop 1
    v_max_f32 v2, v2, v120
    v_sub_f32 v120, 0, v2
    v_sub_f32 v121, 0, v2
    v_sub_f32 v122, 0, v2
    v_sub_f32 v123, 0, v2
    v_sub_f32 v124, 0, v2
    v_sub_f32 v125, 0, v2
    v_sub_f32 v126, 0, v2
    v_sub_f32 v127, 0, v2
    v_sub_f32 v128, 0, v2
    v_sub_f32 v129, 0, v2
    v_sub_f32 v130, 0, v2
    v_sub_f32 v131, 0, v2
    v_sub_f32 v132, 0, v2
    v_sub_f32 v133, 0, v2
    v_sub_f32 v134, 0, v2
    v_sub_f32 v135, 0, v2
    v_mov_b32 v136, 0
    v_mov_b32 v137, 0
    v_mov_b32 v138, 0
    v_mov_b32 v139, 0
    v_mov_b32 v140, 0
    v_mov_b32 v141, 0
    v_mov_b32 v142, 0
    v_mov_b32 v143, 0
    v_mov_b32 v144, 0
    v_mov_b32 v145, 0
    v_mov_b32 v146, 0
    v_mov_b32 v147, 0
    v_mov_b32 v148, 0
    v_mov_b32 v149, 0
    v_mov_b32 v150, 0
    v_mov_b32 v151, 0
    v_mov_b32 v40, 0
    v_mov_b32 v41, 0
    v_mov_b32 v42, 0
    v_mov_b32 v43, 0
    s_mov_b32 s77, 65536
L_slow2_34:
    buffer_load_dwordx4 v[80:83], v1, s[40:43], s77 offen offset:0 sc1
    buffer_load_dwordx4 v[84:87], v1, s[40:43], s77 offen offset:1024 sc1
    buffer_load_dwordx4 v[96:99], v1, s[40:43], s77 offen offset:2048 sc1
    buffer_load_dwordx4 v[100:103], v1, s[40:43], s77 offen offset:3072 sc1
    s_waitcnt vmcnt(0)
    v_mfma_f32_32x32x16_bf16 v[104:119], v[80:83], v[64:67], v[120:135]
    v_mfma_f32_32x32x16_bf16 v[104:119], v[84:87], v[68:71], v[104:119]
    s_nop 15
    v_exp_f32 v104, v104
    v_exp_f32 v105, v105
    v_exp_f32 v106, v106
    v_exp_f32 v107, v107
    v_exp_f32 v108, v108
    v_exp_f32 v109, v109
    v_exp_f32 v110, v110
    v_exp_f32 v111, v111
    v_exp_f32 v112, v112
    v_exp_f32 v113, v113
    v_exp_f32 v114, v114
    v_exp_f32 v115, v115
    v_exp_f32 v116, v116
    v_exp_f32 v117, v117
    v_exp_f32 v118, v118
    v_exp_f32 v119, v119
    s_nop 2
    v_smfmac_f32_32x32x32_bf16 v[136:151], v[96:99], v[104:111], v39
    v_smfmac_f32_32x32x32_bf16 v[136:151], v[100:103], v[112:119], v39
    v_smfmac_f32_16x16x64_bf16 v[40:43], v[48:51], v[104:111], v39
    v_smfmac_f32_16x16x64_bf16 v[40:43], v[48:51], v[112:119], v39
    s_add_u32 s77, s77, 4096
    s_cmp_lt_u32 s77, 327680
    s_cbranch_scc1 L_slow2_34
    s_nop 15
    s_branch L_slowr_23
L_slow_24:
    v_lshlrev_b32 v1, 4, v0
    v_mov_b32 v2, 0xff800000
    s_mov_b32 s77, 65536
L_slow1_35:
    buffer_load_dwordx4 v[80:83], v1, s[40:43], s77 offen sc1
    buffer_load_dwordx4 v[84:87], v1, s[40:43], s77 offen offset:1024 sc1
    s_waitcnt vmcnt(0)
    v_mfma_f32_32x32x16_bf16 v[104:119], v[80:83], v[72:75], 0
    v_mfma_f32_32x32x16_bf16 v[104:119], v[84:87], v[76:79], v[104:119]
    s_nop 15
    v_max3_f32 v2, v2, v104, v105
    v_max3_f32 v2, v2, v106, v107
    v_max3_f32 v2, v2, v108, v109
    v_max3_f32 v2, v2, v110, v111
    v_max3_f32 v2, v2, v112, v113
    v_max3_f32 v2, v2, v114, v115
    v_max3_f32 v2, v2, v116, v117
    v_max3_f32 v2, v2, v118, v119
    s_add_u32 s77, s77, 4096
    s_cmp_lt_u32 s77, 327680
    s_cbranch_scc1 L_slow1_35
    v_mov_b32 v120, v2
    s_nop 1
    v_permlane32_swap_b32 v120, v2
    s_nop 1
    v_max_f32 v2, v2, v120
    v_sub_f32 v120, 0, v2
    v_sub_f32 v121, 0, v2
    v_sub_f32 v122, 0, v2
    v_sub_f32 v123, 0, v2
    v_sub_f32 v124, 0, v2
    v_sub_f32 v125, 0, v2
    v_sub_f32 v126, 0, v2
    v_sub_f32 v127, 0, v2
    v_sub_f32 v128, 0, v2
    v_sub_f32 v129, 0, v2
    v_sub_f32 v130, 0, v2
    v_sub_f32 v131, 0, v2
    v_sub_f32 v132, 0, v2
    v_sub_f32 v133, 0, v2
    v_sub_f32 v134, 0, v2
    v_sub_f32 v135, 0, v2
    v_mov_b32 v152, 0
    v_mov_b32 v153, 0
    v_mov_b32 v154, 0
    v_mov_b32 v155, 0
    v_mov_b32 v156, 0
    v_mov_b32 v157, 0
    v_mov_b32 v158, 0
    v_mov_b32 v159, 0
    v_mov_b32 v160, 0
    v_mov_b32 v161, 0
    v_mov_b32 v162, 0
    v_mov_b32 v163, 0
    v_mov_b32 v164, 0
    v_mov_b32 v165, 0
    v_mov_b32 v166, 0
    v_mov_b32 v167, 0
    v_mov_b32 v44, 0
    v_mov_b32 v45, 0
    v_mov_b32 v46, 0
    v_mov_b32 v47, 0
    s_mov_b32 s77, 65536
L_slow2_36:
    buffer_load_dwordx4 v[80:83], v1, s[40:43], s77 offen offset:0 sc1
    buffer_load_dwordx4 v[84:87], v1, s[40:43], s77 offen offset:1024 sc1
    buffer_load_dwordx4 v[96:99], v1, s[40:43], s77 offen offset:2048 sc1
    buffer_load_dwordx4 v[100:103], v1, s[40:43], s77 offen offset:3072 sc1
    s_waitcnt vmcnt(0)
    v_mfma_f32_32x32x16_bf16 v[104:119], v[80:83], v[72:75], v[120:135]
    v_mfma_f32_32x32x16_bf16 v[104:119], v[84:87], v[76:79], v[104:119]
    s_nop 15
    v_exp_f32 v104, v104
    v_exp_f32 v105, v105
    v_exp_f32 v106, v106
    v_exp_f32 v107, v107
    v_exp_f32 v108, v108
    v_exp_f32 v109, v109
    v_exp_f32 v110, v110
    v_exp_f32 v111, v111
    v_exp_f32 v112, v112
    v_exp_f32 v113, v113
    v_exp_f32 v114, v114
    v_exp_f32 v115, v115
    v_exp_f32 v116, v116
    v_exp_f32 v117, v117
    v_exp_f32 v118, v118
    v_exp_f32 v119, v119
    s_nop 2
    v_smfmac_f32_32x32x32_bf16 v[152:167], v[96:99], v[104:111], v39
    v_smfmac_f32_32x32x32_bf16 v[152:167], v[100:103], v[112:119], v39
    v_smfmac_f32_16x16x64_bf16 v[44:47], v[48:51], v[104:111], v39
    v_smfmac_f32_16x16x64_bf16 v[44:47], v[48:51], v[112:119], v39
    s_add_u32 s77, s77, 4096
    s_cmp_lt_u32 s77, 327680
    s_cbranch_scc1 L_slow2_36
    s_nop 15
    s_branch L_slowr_25
L_hk_28:
    s_cmp_eq_u32 s70, 5
    s_cbranch_scc1 L_hn_38
    s_cmp_eq_u32 s70, 6
    s_cbranch_scc1 L_hn_39
L_hn_37:
    s_lshl4_add_u32 s77, s39, s3
    s_lshl2_add_u32 s77, s77, s38
    s_lshl2_add_u32 s77, s77, 4224
    s_waitcnt vmcnt(9)
    v_mov_b32 v1, 1
    s_mov_b64 exec, 1
    buffer_store_dword v1, off, s[40:43], s77 sc1
    s_mov_b64 exec, -1
    s_branch L_hkr_29
L_hn_38:
    s_lshl1_add_u32 s82, s3, 1
    v_min_u32 v17, 31, v0
    v_lshlrev_b32 v17, 2, v17
    buffer_load_dword v18, v17, s[40:43], s64 offen sc1
    s_branch L_hkr_29
L_hn_39:
    s_waitcnt vmcnt(8)
    v_cmp_ne_u32 vcc, 1, v18
    s_mov_b64 s[100:101], -1
    s_and_b64 vcc, vcc, s[100:101]
    s_cbranch_scc1 L_spin_40
L_spinr_41:
    s_branch L_hkr_29
L_spin_40:
    s_mov_b32 s76, 400000
L_sp_42:
    s_sleep 1
    buffer_load_dword v18, v17, s[40:43], s64 offen sc1
    s_waitcnt vmcnt(0)
    v_cmp_ne_u32 vcc, 1, v18
    s_mov_b64 s[100:101], -1
    s_and_b64 vcc, vcc, s[100:101]
    s_cbranch_scc0 L_spinr_41
    s_sub_u32 s76, s76, 1
    s_cmp_lg_u32 s76, 0
    s_cbranch_scc1 L_sp_42
    s_branch L_spinr_41
L_g1hi_pre:
    v_mov_b32 v24, 0
    v_mov_b32 v25, 0
    v_mov_b32 v26, 0
    v_mov_b32 v27, 0
    v_and_b32 v1, 31, v0
    v_lshrrev_b32 v2, 5, v0
    v_bfe_u32 v3, v0, 1, 3
    v_xor_b32 v2, v2, v3
    v_lshlrev_b32 v2, 4, v2
    v_lshl_add_u32 v2, v1, 7, v2
    v_add_u32 v56, s75, v2
    v_xor_b32 v57, 32, v56
    v_xor_b32 v58, 64, v56
    v_xor_b32 v59, 96, v56
    s_and_b32 s78, s3, 1
    s_sub_u32 s79, s78, 1
    v_bfe_u32 v1, v0, 2, 2
    v_lshrrev_b32 v2, 5, v0
    v_lshl_add_u32 v1, v2, 3, v1
    v_bfe_u32 v2, v0, 4, 1
    v_lshlrev_b32 v2, 5, v2
    v_lshl_add_u32 v1, v1, 6, v2
    v_lshrrev_b32 v2, 1, v0
    v_xor_b32 v2, v2, v0
    v_and_b32 v2, 1, v2
    v_mul_u32_u24 v2, 3, v2
    v_and_b32 v2, s79, v2
    v_xor_b32 v2, v2, v0
    v_and_b32 v2, 3, v2
    v_lshl_add_u32 v1, v2, 3, v1
    v_add_u32 v60, s75, v1
    s_lshl_b32 s77, s81, 12
    s_add_u32 s77, s77, 0x24000
    v_lshl_add_u32 v61, v0, 4, s77
    v_mfma_f32_32x32x16_bf16 v[128:143], v[24:27], v[24:27], 0
    v_mfma_f32_32x32x16_bf16 v[144:159], v[24:27], v[24:27], 0
    v_mfma_f32_32x32x16_bf16 v[160:175], v[24:27], v[24:27], 0
    v_mfma_f32_32x32x16_bf16 v[176:191], v[24:27], v[24:27], 0
    v_mfma_f32_32x32x16_bf16 v[192:207], v[24:27], v[24:27], 0
    v_mfma_f32_32x32x16_bf16 v[208:223], v[24:27], v[24:27], 0
    v_mfma_f32_32x32x16_bf16 v[224:239], v[24:27], v[24:27], 0
    v_mfma_f32_32x32x16_bf16 v[240:255], v[24:27], v[24:27], 0
    s_branch L_first
L_g1x_4:
    s_barrier
    ds_read_b128 v[32:35], v61 offset:0
    ds_read_b128 v[36:39], v61 offset:1024
    ds_read_b128 v[40:43], v61 offset:2048
    ds_read_b128 v[44:47], v61 offset:3072
    s_mov_b32 s40, s36
    s_mov_b32 s41, s37
    s_mov_b32 s42, 0x10000000
    s_mov_b32 s43, 0x20000
    s_mov_b32 s56, s32
    s_mov_b32 s57, s33
    s_mov_b32 s58, 0x1000000
    s_mov_b32 s59, 0x20000
    s_mov_b32 s60, s34
    s_mov_b32 s61, s35
    s_mov_b32 s62, 0x100
    s_mov_b32 s63, 0x20000
    s_lshr_b32 s79, s81, 1
    s_lshl1_add_u32 s64, s69, s79
    v_and_b32 v29, 15, v0
    s_lshl_b32 s77, s79, 8
    v_lshl_add_u32 v29, v29, 4, s77
    s_and_b32 s80, s81, 1
    s_lshl_b32 s78, s80, 14
    s_lshl_b32 s79, s79, 13
    s_add_u32 s79, s79, 32768
    v_and_b32 v1, 15, v0
    v_lshrrev_b32 v2, 4, v0
    v_bfe_u32 v3, v0, 1, 3
    v_xor_b32 v2, v2, v3
    v_lshlrev_b32 v2, 4, v2
    v_lshl_add_u32 v2, v1, 7, v2
    v_add_u32 v8, s78, v2
    v_xor_b32 v9, 64, v8
    v_add_u32 v10, s79, v2
    v_xor_b32 v11, 64, v10
    v_lshrrev_b32 v2, 4, v0
    s_lshl_b32 s80, s80, 2
    v_add_u32 v2, s80, v2
    v_lshl_add_u32 v28, v2, 9, v29
    s_lshl_b32 s64, s64, 7
    s_add_u32 s64, s64, 8192
    s_lshl_b32 s65, s69, 9
    s_add_u32 s65, s65, 393216
    v_mov_b32 v12, 0
    v_mov_b32 v13, 0
    v_mov_b32 v14, 0
    v_mov_b32 v15, 0
    s_branch L_g1kv_5
L_g1hi_2:
    s_setprio 1
    s_mov_b32 s80, 0
    s_mov_b32 s70, 0
    v_add_u32 v1, 147456, v29
    s_barrier
    ds_read_b128 v[32:35], v8 offset:0
    ds_read_b128 v[36:39], v9 offset:0
    ds_read_b128 v[64:67], v10 offset:0
    ds_read_b128 v[68:71], v11 offset:0
    ds_read_b128 v[72:75], v10 offset:2048
    ds_read_b128 v[76:79], v11 offset:2048
    ds_read_b128 v[80:83], v10 offset:4096
    ds_read_b128 v[84:87], v11 offset:4096
    ds_read_b128 v[88:91], v10 offset:6144
    ds_read_b128 v[92:95], v11 offset:6144
    ds_read_b128 v[40:43], v8 offset:2048
    ds_read_b128 v[44:47], v9 offset:2048
    .p2align 3
L_a1_43:
    s_waitcnt lgkmcnt(2)
    v_mfma_f32_16x16x32_bf16 v[128:131], v[32:35], v[64:67], v[128:131]
    ds_read_b128 v[48:51], v8 offset:4096
    v_mfma_f32_16x16x32_bf16 v[128:131], v[36:39], v[68:71], v[128:131]
    ds_read_b128 v[52:55], v9 offset:4096
    v_mfma_f32_16x16x32_bf16 v[132:135], v[32:35], v[72:75], v[132:135]
    v_mfma_f32_16x16x32_bf16 v[132:135], v[36:39], v[76:79], v[132:135]
    v_mfma_f32_16x16x32_bf16 v[136:139], v[32:35], v[80:83], v[136:139]
    v_mfma_f32_16x16x32_bf16 v[136:139], v[36:39], v[84:87], v[136:139]
    v_mfma_f32_16x16x32_bf16 v[140:143], v[32:35], v[88:91], v[140:143]
    v_mfma_f32_16x16x32_bf16 v[140:143], v[36:39], v[92:95], v[140:143]
    s_waitcnt lgkmcnt(2)
    v_mfma_f32_16x16x32_bf16 v[156:159], v[40:43], v[88:91], v[156:159]
    ds_read_b128 v[12:15], v1 offset:0
    v_mfma_f32_16x16x32_bf16 v[156:159], v[44:47], v[92:95], v[156:159]
    ds_read_b128 v[16:19], v1 offset:512
    v_mfma_f32_16x16x32_bf16 v[152:155], v[40:43], v[80:83], v[152:155]
    ds_read_b128 v[20:23], v1 offset:1024
    v_mfma_f32_16x16x32_bf16 v[152:155], v[44:47], v[84:87], v[152:155]
    ds_read_b128 v[4:7], v1 offset:1536
    v_mfma_f32_16x16x32_bf16 v[148:151], v[40:43], v[72:75], v[148:151]
    ds_read_b128 v[24:27], v1 offset:2048
    v_mfma_f32_16x16x32_bf16 v[148:151], v[44:47], v[76:79], v[148:151]
    ds_read_b128 v[56:59], v8 offset:6144
    v_mfma_f32_16x16x32_bf16 v[144:147], v[40:43], v[64:67], v[144:147]
    ds_read_b128 v[60:63], v9 offset:6144
    v_mfma_f32_16x16x32_bf16 v[144:147], v[44:47], v[68:71], v[144:147]
    s_waitcnt lgkmcnt(2)
    v_mfma_f32_16x16x32_bf16 v[160:163], v[48:51], v[64:67], v[160:163]
    ds_read_b128 v[32:35], v8 offset:8192
    v_mfma_f32_16x16x32_bf16 v[160:163], v[52:55], v[68:71], v[160:163]
    ds_read_b128 v[36:39], v9 offset:8192
    v_mfma_f32_16x16x32_bf16 v[164:167], v[48:51], v[72:75], v[164:167]
    v_mfma_f32_16x16x32_bf16 v[164:167], v[52:55], v[76:79], v[164:167]
    v_mfma_f32_16x16x32_bf16 v[168:171], v[48:51], v[80:83], v[168:171]
    v_mfma_f32_16x16x32_bf16 v[168:171], v[52:55], v[84:87], v[168:171]
    v_mfma_f32_16x16x32_bf16 v[172:175], v[48:51], v[88:91], v[172:175]
    v_mfma_f32_16x16x32_bf16 v[172:175], v[52:55], v[92:95], v[172:175]
    s_waitcnt lgkmcnt(2)
    v_mfma_f32_16x16x32_bf16 v[188:191], v[56:59], v[88:91], v[188:191]
    ds_read_b128 v[40:43], v8 offset:10240
    v_mfma_f32_16x16x32_bf16 v[188:191], v[60:63], v[92:95], v[188:191]
    ds_read_b128 v[44:47], v9 offset:10240
    v_mfma_f32_16x16x32_bf16 v[184:187], v[56:59], v[80:83], v[184:187]
    v_mfma_f32_16x16x32_bf16 v[184:187], v[60:63], v[84:87], v[184:187]
    v_mfma_f32_16x16x32_bf16 v[180:183], v[56:59], v[72:75], v[180:183]
    v_mfma_f32_16x16x32_bf16 v[180:183], v[60:63], v[76:79], v[180:183]
    v_mfma_f32_16x16x32_bf16 v[176:179], v[56:59], v[64:67], v[176:179]
    v_mfma_f32_16x16x32_bf16 v[176:179], v[60:63], v[68:71], v[176:179]
    s_waitcnt lgkmcnt(2)
    v_mfma_f32_16x16x32_bf16 v[192:195], v[32:35], v[64:67], v[192:195]
    ds_read_b128 v[48:51], v8 offset:12288
    v_mfma_f32_16x16x32_bf16 v[192:195], v[36:39], v[68:71], v[192:195]
    ds_read_b128 v[52:55], v9 offset:12288
    v_mfma_f32_16x16x32_bf16 v[196:199], v[32:35], v[72:75], v[196:199]
    s_mov_b32 s79, 49152
    v_mfma_f32_16x16x32_bf16 v[196:199], v[36:39], v[76:79], v[196:199]
    s_cmp_eq_u32 s80, 98304
    v_mfma_f32_16x16x32_bf16 v[200:203], v[32:35], v[80:83], v[200:203]
    s_cmov_b32 s79, 0xfffe8000
    v_mfma_f32_16x16x32_bf16 v[200:203], v[36:39], v[84:87], v[200:203]
    s_add_u32 s80, s80, s79
    v_mfma_f32_16x16x32_bf16 v[204:207], v[32:35], v[88:91], v[204:207]
    v_mfma_f32_16x16x32_bf16 v[204:207], v[36:39], v[92:95], v[204:207]
    s_waitcnt lgkmcnt(2)
    v_mfma_f32_16x16x32_bf16 v[220:223], v[40:43], v[88:91], v[220:223]
    ds_read_b128 v[56:59], v8 offset:14336
    v_mfma_f32_16x16x32_bf16 v[220:223], v[44:47], v[92:95], v[220:223]
    ds_read_b128 v[60:63], v9 offset:14336
    v_mfma_f32_16x16x32_bf16 v[216:219], v[40:43], v[80:83], v[216:219]
    v_add_u32 v8, s79, v8
    v_mfma_f32_16x16x32_bf16 v[216:219], v[44:47], v[84:87], v[216:219]
    v_add_u32 v9, s79, v9
    v_mfma_f32_16x16x32_bf16 v[212:215], v[40:43], v[72:75], v[212:215]
    v_add_u32 v10, s79, v10
    v_mfma_f32_16x16x32_bf16 v[212:215], v[44:47], v[76:79], v[212:215]
    v_add_u32 v11, s79, v11
    v_mfma_f32_16x16x32_bf16 v[208:211], v[40:43], v[64:67], v[208:211]
    v_mfma_f32_16x16x32_bf16 v[208:211], v[44:47], v[68:71], v[208:211]
    s_waitcnt lgkmcnt(0)
    v_mfma_f32_16x16x32_bf16 v[224:227], v[48:51], v[64:67], v[224:227]
    s_barrier
    v_mfma_f32_16x16x32_bf16 v[224:227], v[52:55], v[68:71], v[224:227]
    ds_read_b128 v[32:35], v8 offset:0
    v_mfma_f32_16x16x32_bf16 v[228:231], v[48:51], v[72:75], v[228:231]
    ds_read_b128 v[36:39], v9 offset:0
    v_mfma_f32_16x16x32_bf16 v[228:231], v[52:55], v[76:79], v[228:231]
    ds_read_b128 v[96:99], v10 offset:0
    v_mfma_f32_16x16x32_bf16 v[232:235], v[48:51], v[80:83], v[232:235]
    ds_read_b128 v[100:103], v11 offset:0
    v_mfma_f32_16x16x32_bf16 v[232:235], v[52:55], v[84:87], v[232:235]
    ds_read_b128 v[104:107], v10 offset:2048
    v_mfma_f32_16x16x32_bf16 v[236:239], v[48:51], v[88:91], v[236:239]
    ds_read_b128 v[108:111], v11 offset:2048
    v_mfma_f32_16x16x32_bf16 v[236:239], v[52:55], v[92:95], v[236:239]
    ds_read_b128 v[112:115], v10 offset:4096
    v_mfma_f32_16x16x32_bf16 v[252:255], v[56:59], v[88:91], v[252:255]
    ds_read_b128 v[116:119], v11 offset:4096
    v_mfma_f32_16x16x32_bf16 v[252:255], v[60:63], v[92:95], v[252:255]
    ds_read_b128 v[120:123], v10 offset:6144
    v_mfma_f32_16x16x32_bf16 v[248:251], v[56:59], v[80:83], v[248:251]
    ds_read_b128 v[124:127], v11 offset:6144
    v_mfma_f32_16x16x32_bf16 v[248:251], v[60:63], v[84:87], v[248:251]
    ds_read_b128 v[40:43], v8 offset:2048
    v_mfma_f32_16x16x32_bf16 v[244:247], v[56:59], v[72:75], v[244:247]
    ds_read_b128 v[44:47], v9 offset:2048
    v_mfma_f32_16x16x32_bf16 v[244:247], v[60:63], v[76:79], v[244:247]
    v_mfma_f32_16x16x32_bf16 v[240:243], v[56:59], v[64:67], v[240:243]
    v_mfma_f32_16x16x32_bf16 v[240:243], v[60:63], v[68:71], v[240:243]
    s_waitcnt lgkmcnt(2)
    v_mfma_f32_16x16x32_bf16 v[128:131], v[32:35], v[96:99], v[128:131]
    ds_read_b128 v[48:51], v8 offset:4096
    v_mfma_f32_16x16x32_bf16 v[128:131], v[36:39], v[100:103], v[128:131]
    ds_read_b128 v[52:55], v9 offset:4096
    v_mfma_f32_16x16x32_bf16 v[132:135], v[32:35], v[104:107], v[132:135]
    v_mfma_f32_16x16x32_bf16 v[132:135], v[36:39], v[108:111], v[132:135]
    v_mfma_f32_16x16x32_bf16 v[136:139], v[32:35], v[112:115], v[136:139]
    v_mfma_f32_16x16x32_bf16 v[136:139], v[36:39], v[116:119], v[136:139]
    v_mfma_f32_16x16x32_bf16 v[140:143], v[32:35], v[120:123], v[140:143]
    v_mfma_f32_16x16x32_bf16 v[140:143], v[36:39], v[124:127], v[140:143]
    s_waitcnt lgkmcnt(2)
    v_mfma_f32_16x16x32_bf16 v[156:159], v[40:43], v[120:123], v[156:159]
    ds_read_b128 v[56:59], v8 offset:6144
    v_mfma_f32_16x16x32_bf16 v[156:159], v[44:47], v[124:127], v[156:159]
    ds_read_b128 v[60:63], v9 offset:6144
    v_mfma_f32_16x16x32_bf16 v[152:155], v[40:43], v[112:115], v[152:155]
    v_mfma_f32_16x16x32_bf16 v[152:155], v[44:47], v[116:119], v[152:155]
    v_mfma_f32_16x16x32_bf16 v[148:151], v[40:43], v[104:107], v[148:151]
    v_mfma_f32_16x16x32_bf16 v[148:151], v[44:47], v[108:111], v[148:151]
    v_mfma_f32_16x16x32_bf16 v[144:147], v[40:43], v[96:99], v[144:147]
    v_mfma_f32_16x16x32_bf16 v[144:147], v[44:47], v[100:103], v[144:147]
    s_waitcnt lgkmcnt(2)
    v_mfma_f32_16x16x32_bf16 v[160:163], v[48:51], v[96:99], v[160:163]
    ds_read_b128 v[32:35], v8 offset:8192
    v_mfma_f32_16x16x32_bf16 v[160:163], v[52:55], v[100:103], v[160:163]
    ds_read_b128 v[36:39], v9 offset:8192
    v_mfma_f32_16x16x32_bf16 v[164:167], v[48:51], v[104:107], v[164:167]
    v_mfma_f32_16x16x32_bf16 v[164:167], v[52:55], v[108:111], v[164:167]
    v_mfma_f32_16x16x32_bf16 v[168:171], v[48:51], v[112:115], v[168:171]
    v_mfma_f32_16x16x32_bf16 v[168:171], v[52:55], v[116:119], v[168:171]
    v_mfma_f32_16x16x32_bf16 v[172:175], v[48:51], v[120:123], v[172:175]
    v_mfma_f32_16x16x32_bf16 v[172:175], v[52:55], v[124:127], v[172:175]
    s_waitcnt lgkmcnt(2)
    v_mfma_f32_16x16x32_bf16 v[188:191], v[56:59], v[120:123], v[188:191]
    ds_read_b128 v[40:43], v8 offset:10240
    v_mfma_f32_16x16x32_bf16 v[188:191], v[60:63], v[124:127], v[188:191]
    ds_read_b128 v[44:47], v9 offset:10240
    v_mfma_f32_16x16x32_bf16 v[184:187], v[56:59], v[112:115], v[184:187]
    v_mfma_f32_16x16x32_bf16 v[184:187], v[60:63], v[116:119], v[184:187]
    v_mfma_f32_16x16x32_bf16 v[180:183], v[56:59], v[104:107], v[180:183]
    v_mfma_f32_16x16x32_bf16 v[180:183], v[60:63], v[108:111], v[180:183]
    v_mfma_f32_16x16x32_bf16 v[176:179], v[56:59], v[96:99], v[176:179]
    v_mfma_f32_16x16x32_bf16 v[176:179], v[60:63], v[100:103], v[176:179]
    s_waitcnt lgkmcnt(2)
    v_mfma_f32_16x16x32_bf16 v[192:195], v[32:35], v[96:99], v[192:195]
    ds_read_b128 v[48:51], v8 offset:12288
    v_mfma_f32_16x16x32_bf16 v[192:195], v[36:39], v[100:103], v[192:195]
    ds_read_b128 v[52:55], v9 offset:12288
    v_mfma_f32_16x16x32_bf16 v[196:199], v[32:35], v[104:107], v[196:199]
    s_mov_b32 s79, 49152
    v_mfma_f32_16x16x32_bf16 v[196:199], v[36:39], v[108:111], v[196:199]
    s_cmp_eq_u32 s80, 98304
    v_mfma_f32_16x16x32_bf16 v[200:203], v[32:35], v[112:115], v[200:203]
    s_cmov_b32 s79, 0xfffe8000
    v_mfma_f32_16x16x32_bf16 v[200:203], v[36:39], v[116:119], v[200:203]
    s_add_u32 s80, s80, s79
    v_mfma_f32_16x16x32_bf16 v[204:207], v[32:35], v[120:123], v[204:207]
    v_mfma_f32_16x16x32_bf16 v[204:207], v[36:39], v[124:127], v[204:207]
    s_waitcnt lgkmcnt(2)
    v_mfma_f32_16x16x32_bf16 v[220:223], v[40:43], v[120:123], v[220:223]
    ds_read_b128 v[56:59], v8 offset:14336
    v_mfma_f32_16x16x32_bf16 v[220:223], v[44:47], v[124:127], v[220:223]
    ds_read_b128 v[60:63], v9 offset:14336
    v_mfma_f32_16x16x32_bf16 v[216:219], v[40:43], v[112:115], v[216:219]
    v_add_u32 v8, s79, v8
    v_mfma_f32_16x16x32_bf16 v[216:219], v[44:47], v[116:119], v[216:219]
    v_add_u32 v9, s79, v9
    v_mfma_f32_16x16x32_bf16 v[212:215], v[40:43], v[104:107], v[212:215]
    v_add_u32 v10, s79, v10
    v_mfma_f32_16x16x32_bf16 v[212:215], v[44:47], v[108:111], v[212:215]
    v_add_u32 v11, s79, v11
    v_mfma_f32_16x16x32_bf16 v[208:211], v[40:43], v[96:99], v[208:211]
    v_mfma_f32_16x16x32_bf16 v[208:211], v[44:47], v[100:103], v[208:211]
    s_waitcnt lgkmcnt(0)
    v_mfma_f32_16x16x32_bf16 v[224:227], v[48:51], v[96:99], v[224:227]
    s_barrier
    v_mfma_f32_16x16x32_bf16 v[224:227], v[52:55], v[100:103], v[224:227]
    ds_read_b128 v[32:35], v8 offset:0
    v_mfma_f32_16x16x32_bf16 v[228:231], v[48:51], v[104:107], v[228:231]
    ds_read_b128 v[36:39], v9 offset:0
    v_mfma_f32_16x16x32_bf16 v[228:231], v[52:55], v[108:111], v[228:231]
    ds_read_b128 v[64:67], v10 offset:0
    v_mfma_f32_16x16x32_bf16 v[232:235], v[48:51], v[112:115], v[232:235]
    ds_read_b128 v[68:71], v11 offset:0
    v_mfma_f32_16x16x32_bf16 v[232:235], v[52:55], v[116:119], v[232:235]
    ds_read_b128 v[72:75], v10 offset:2048
    v_mfma_f32_16x16x32_bf16 v[236:239], v[48:51], v[120:123], v[236:239]
    ds_read_b128 v[76:79], v11 offset:2048
    v_mfma_f32_16x16x32_bf16 v[236:239], v[52:55], v[124:127], v[236:239]
    ds_read_b128 v[80:83], v10 offset:4096
    v_mfma_f32_16x16x32_bf16 v[252:255], v[56:59], v[120:123], v[252:255]
    ds_read_b128 v[84:87], v11 offset:4096
    v_mfma_f32_16x16x32_bf16 v[252:255], v[60:63], v[124:127], v[252:255]
    ds_read_b128 v[88:91], v10 offset:6144
    v_mfma_f32_16x16x32_bf16 v[248:251], v[56:59], v[112:115], v[248:251]
    ds_read_b128 v[92:95], v11 offset:6144
    v_mfma_f32_16x16x32_bf16 v[248:251], v[60:63], v[116:119], v[248:251]
    ds_read_b128 v[40:43], v8 offset:2048
    v_mfma_f32_16x16x32_bf16 v[244:247], v[56:59], v[104:107], v[244:247]
    ds_read_b128 v[44:47], v9 offset:2048
    v_mfma_f32_16x16x32_bf16 v[244:247], v[60:63], v[108:111], v[244:247]
    s_add_u32 s70, s70, 1
    v_mfma_f32_16x16x32_bf16 v[240:243], v[56:59], v[96:99], v[240:243]
    s_cmp_lg_u32 s70, 8
    v_mfma_f32_16x16x32_bf16 v[240:243], v[60:63], v[100:103], v[240:243]
    s_cbranch_scc1 L_a1_43
    v_pk_mov_b32 v[48:49], v[128:129], v[128:129] op_sel:[0,1]
    v_pk_mov_b32 v[50:51], v[136:137], v[136:137] op_sel:[0,1]
    v_pk_fma_f32 v[52:53], v[14:15], v[50:51], v[130:131] op_sel:[0,0,0] op_sel_hi:[0,1,1] neg_lo:[1,0,0] neg_hi:[1,0,0]
    v_pk_fma_f32 v[54:55], v[14:15], v[48:49], v[138:139] op_sel:[0,0,0] op_sel_hi:[0,1,1]
    v_pk_fma_f32 v[48:49], v[12:13], v[48:49], v[52:53] op_sel:[0,0,0] op_sel_hi:[0,1,1]
    v_pk_fma_f32 v[50:51], v[12:13], v[50:51], v[54:55] op_sel:[0,0,0] op_sel_hi:[0,1,1]
    v_pk_fma_f32 v[52:53], v[14:15], v[50:51], v[144:145] op_sel:[0,0,0] op_sel_hi:[0,1,1] neg_lo:[1,0,0] neg_hi:[1,0,0]
    v_pk_fma_f32 v[54:55], v[14:15], v[48:49], v[152:153] op_sel:[0,0,0] op_sel_hi:[0,1,1]
    v_pk_fma_f32 v[48:49], v[12:13], v[48:49], v[52:53] op_sel:[0,0,0] op_sel_hi:[0,1,1]
    v_pk_fma_f32 v[50:51], v[12:13], v[50:51], v[54:55] op_sel:[0,0,0] op_sel_hi:[0,1,1]
    v_pk_fma_f32 v[52:53], v[14:15], v[50:51], v[146:147] op_sel:[0,0,0] op_sel_hi:[0,1,1] neg_lo:[1,0,0] neg_hi:[1,0,0]
    v_pk_fma_f32 v[54:55], v[14:15], v[48:49], v[154:155] op_sel:[0,0,0] op_sel_hi:[0,1,1]
    v_pk_fma_f32 v[48:49], v[12:13], v[48:49], v[52:53] op_sel:[0,0,0] op_sel_hi:[0,1,1]
    v_pk_fma_f32 v[50:51], v[12:13], v[50:51], v[54:55] op_sel:[0,0,0] op_sel_hi:[0,1,1]
    v_pk_fma_f32 v[52:53], v[14:15], v[50:51], v[160:161] op_sel:[0,0,0] op_sel_hi:[0,1,1] neg_lo:[1,0,0] neg_hi:[1,0,0]
    v_pk_fma_f32 v[54:55], v[14:15], v[48:49], v[168:169] op_sel:[0,0,0] op_sel_hi:[0,1,1]
    v_pk_fma_f32 v[48:49], v[12:13], v[48:49], v[52:53] op_sel:[0,0,0] op_sel_hi:[0,1,1]
    v_pk_fma_f32 v[50:51], v[12:13], v[50:51], v[54:55] op_sel:[0,0,0] op_sel_hi:[0,1,1]
    v_pk_fma_f32 v[52:53], v[14:15], v[50:51], v[162:163] op_sel:[0,0,0] op_sel_hi:[0,1,1] neg_lo:[1,0,0] neg_hi:[1,0,0]
    v_pk_fma_f32 v[54:55], v[14:15], v[48:49], v[170:171] op_sel:[0,0,0] op_sel_hi:[0,1,1]
    v_pk_fma_f32 v[48:49], v[12:13], v[48:49], v[52:53] op_sel:[0,0,0] op_sel_hi:[0,1,1]
    v_pk_fma_f32 v[50:51], v[12:13], v[50:51], v[54:55] op_sel:[0,0,0] op_sel_hi:[0,1,1]
    v_pk_fma_f32 v[52:53], v[14:15], v[50:51], v[176:177] op_sel:[0,0,0] op_sel_hi:[0,1,1] neg_lo:[1,0,0] neg_hi:[1,0,0]
    v_pk_fma_f32 v[54:55], v[14:15], v[48:49], v[184:185] op_sel:[0,0,0] op_sel_hi:[0,1,1]
    v_pk_fma_f32 v[48:49], v[12:13], v[48:49], v[52:53] op_sel:[0,0,0] op_sel_hi:[0,1,1]
    v_pk_fma_f32 v[50:51], v[12:13], v[50:51], v[54:55] op_sel:[0,0,0] op_sel_hi:[0,1,1]
    v_pk_fma_f32 v[52:53], v[14:15], v[50:51], v[178:179] op_sel:[0,0,0] op_sel_hi:[0,1,1] neg_lo:[1,0,0] neg_hi:[1,0,0]
    v_pk_fma_f32 v[54:55], v[14:15], v[48:49], v[186:187] op_sel:[0,0,0] op_sel_hi:[0,1,1]
    v_pk_fma_f32 v[48:49], v[12:13], v[48:49], v[52:53] op_sel:[0,0,0] op_sel_hi:[0,1,1]
    v_pk_fma_f32 v[50:51], v[12:13], v[50:51], v[54:55] op_sel:[0,0,0] op_sel_hi:[0,1,1]
    v_pk_fma_f32 v[52:53], v[14:15], v[50:51], v[192:193] op_sel:[0,0,0] op_sel_hi:[0,1,1] neg_lo:[1,0,0] neg_hi:[1,0,0]
    v_pk_fma_f32 v[54:55], v[14:15], v[48:49], v[200:201] op_sel:[0,0,0] op_sel_hi:[0,1,1]
    v_pk_fma_f32 v[48:49], v[12:13], v[48:49], v[52:53] op_sel:[0,0,0] op_sel_hi:[0,1,1]
    v_pk_fma_f32 v[50:51], v[12:13], v[50:51], v[54:55] op_sel:[0,0,0] op_sel_hi:[0,1,1]
    v_pk_fma_f32 v[52:53], v[14:15], v[50:51], v[194:195] op_sel:[0,0,0] op_sel_hi:[0,1,1] neg_lo:[1,0,0] neg_hi:[1,0,0]
    v_pk_fma_f32 v[54:55], v[14:15], v[48:49], v[202:203] op_sel:[0,0,0] op_sel_hi:[0,1,1]
    v_pk_fma_f32 v[48:49], v[12:13], v[48:49], v[52:53] op_sel:[0,0,0] op_sel_hi:[0,1,1]
    v_pk_fma_f32 v[50:51], v[12:13], v[50:51], v[54:55] op_sel:[0,0,0] op_sel_hi:[0,1,1]
    v_pk_fma_f32 v[52:53], v[14:15], v[50:51], v[208:209] op_sel:[0,0,0] op_sel_hi:[0,1,1] neg_lo:[1,0,0] neg_hi:[1,0,0]
    v_pk_fma_f32 v[54:55], v[14:15], v[48:49], v[216:217] op_sel:[0,0,0] op_sel_hi:[0,1,1]
    v_pk_fma_f32 v[48:49], v[12:13], v[48:49], v[52:53] op_sel:[0,0,0] op_sel_hi:[0,1,1]
    v_pk_fma_f32 v[50:51], v[12:13], v[50:51], v[54:55] op_sel:[0,0,0] op_sel_hi:[0,1,1]
    v_pk_fma_f32 v[52:53], v[14:15], v[50:51], v[210:211] op_sel:[0,0,0] op_sel_hi:[0,1,1] neg_lo:[1,0,0] neg_hi:[1,0,0]
    v_pk_fma_f32 v[54:55], v[14:15], v[48:49], v[218:219] op_sel:[0,0,0] op_sel_hi:[0,1,1]
    v_pk_fma_f32 v[48:49], v[12:13], v[48:49], v[52:53] op_sel:[0,0,0] op_sel_hi:[0,1,1]
    v_pk_fma_f32 v[50:51], v[12:13], v[50:51], v[54:55] op_sel:[0,0,0] op_sel_hi:[0,1,1]
    v_pk_fma_f32 v[52:53], v[14:15], v[50:51], v[224:225] op_sel:[0,0,0] op_sel_hi:[0,1,1] neg_lo:[1,0,0] neg_hi:[1,0,0]
    v_pk_fma_f32 v[54:55], v[14:15], v[48:49], v[232:233] op_sel:[0,0,0] op_sel_hi:[0,1,1]
    v_pk_fma_f32 v[48:49], v[12:13], v[48:49], v[52:53] op_sel:[0,0,0] op_sel_hi:[0,1,1]
    v_pk_fma_f32 v[50:51], v[12:13], v[50:51], v[54:55] op_sel:[0,0,0] op_sel_hi:[0,1,1]
    v_pk_fma_f32 v[52:53], v[14:15], v[50:51], v[226:227] op_sel:[0,0,0] op_sel_hi:[0,1,1] neg_lo:[1,0,0] neg_hi:[1,0,0]
    v_pk_fma_f32 v[54:55], v[14:15], v[48:49], v[234:235] op_sel:[0,0,0] op_sel_hi:[0,1,1]
    v_pk_fma_f32 v[48:49], v[12:13], v[48:49], v[52:53] op_sel:[0,0,0] op_sel_hi:[0,1,1]
    v_pk_fma_f32 v[50:51], v[12:13], v[50:51], v[54:55] op_sel:[0,0,0] op_sel_hi:[0,1,1]
    v_pk_fma_f32 v[52:53], v[14:15], v[50:51], v[240:241] op_sel:[0,0,0] op_sel_hi:[0,1,1] neg_lo:[1,0,0] neg_hi:[1,0,0]
    v_pk_fma_f32 v[54:55], v[14:15], v[48:49], v[248:249] op_sel:[0,0,0] op_sel_hi:[0,1,1]
    v_pk_fma_f32 v[48:49], v[12:13], v[48:49], v[52:53] op_sel:[0,0,0] op_sel_hi:[0,1,1]
    v_pk_fma_f32 v[50:51], v[12:13], v[50:51], v[54:55] op_sel:[0,0,0] op_sel_hi:[0,1,1]
    v_pk_fma_f32 v[52:53], v[14:15], v[50:51], v[242:243] op_sel:[0,0,0] op_sel_hi:[0,1,1] neg_lo:[1,0,0] neg_hi:[1,0,0]
    v_pk_fma_f32 v[54:55], v[14:15], v[48:49], v[250:251] op_sel:[0,0,0] op_sel_hi:[0,1,1]
    v_pk_fma_f32 v[48:49], v[12:13], v[48:49], v[52:53] op_sel:[0,0,0] op_sel_hi:[0,1,1]
    v_pk_fma_f32 v[50:51], v[12:13], v[50:51], v[54:55] op_sel:[0,0,0] op_sel_hi:[0,1,1]
    v_mov_b32 v30, v48
    v_mov_b32 v2, v50
    v_fma_f32 v124, -v22, v50, v49
    v_fma_f32 v126, v22, v48, v51
    v_fmac_f32 v124, v20, v48
    v_fmac_f32 v126, v20, v50
    v_pk_mov_b32 v[48:49], v[132:133], v[132:133] op_sel:[0,1]
    v_pk_mov_b32 v[50:51], v[140:141], v[140:141] op_sel:[0,1]
    v_pk_fma_f32 v[52:53], v[14:15], v[50:51], v[134:135] op_sel:[1,0,0] op_sel_hi:[1,1,1] neg_lo:[1,0,0] neg_hi:[1,0,0]
    v_pk_fma_f32 v[54:55], v[14:15], v[48:49], v[142:143] op_sel:[1,0,0] op_sel_hi:[1,1,1]
    v_pk_fma_f32 v[48:49], v[12:13], v[48:49], v[52:53] op_sel:[1,0,0] op_sel_hi:[1,1,1]
    v_pk_fma_f32 v[50:51], v[12:13], v[50:51], v[54:55] op_sel:[1,0,0] op_sel_hi:[1,1,1]
    v_pk_fma_f32 v[52:53], v[14:15], v[50:51], v[148:149] op_sel:[1,0,0] op_sel_hi:[1,1,1] neg_lo:[1,0,0] neg_hi:[1,0,0]
    v_pk_fma_f32 v[54:55], v[14:15], v[48:49], v[156:157] op_sel:[1,0,0] op_sel_hi:[1,1,1]
    v_pk_fma_f32 v[48:49], v[12:13], v[48:49], v[52:53] op_sel:[1,0,0] op_sel_hi:[1,1,1]
    v_pk_fma_f32 v[50:51], v[12:13], v[50:51], v[54:55] op_sel:[1,0,0] op_sel_hi:[1,1,1]
    v_pk_fma_f32 v[52:53], v[14:15], v[50:51], v[150:151] op_sel:[1,0,0] op_sel_hi:[1,1,1] neg_lo:[1,0,0] neg_hi:[1,0,0]
    v_pk_fma_f32 v[54:55], v[14:15], v[48:49], v[158:159] op_sel:[1,0,0] op_sel_hi:[1,1,1]
    v_pk_fma_f32 v[48:49], v[12:13], v[48:49], v[52:53] op_sel:[1,0,0] op_sel_hi:[1,1,1]
    v_pk_fma_f32 v[50:51], v[12:13], v[50:51], v[54:55] op_sel:[1,0,0] op_sel_hi:[1,1,1]
    v_pk_fma_f32 v[52:53], v[14:15], v[50:51], v[164:165] op_sel:[1,0,0] op_sel_hi:[1,1,1] neg_lo:[1,0,0] neg_hi:[1,0,0]
    v_pk_fma_f32 v[54:55], v[14:15], v[48:49], v[172:173] op_sel:[1,0,0] op_sel_hi:[1,1,1]
    v_pk_fma_f32 v[48:49], v[12:13], v[48:49], v[52:53] op_sel:[1,0,0] op_sel_hi:[1,1,1]
    v_pk_fma_f32 v[50:51], v[12:13], v[50:51], v[54:55] op_sel:[1,0,0] op_sel_hi:[1,1,1]
    v_pk_fma_f32 v[52:53], v[14:15], v[50:51], v[166:167] op_sel:[1,0,0] op_sel_hi:[1,1,1] neg_lo:[1,0,0] neg_hi:[1,0,0]
    v_pk_fma_f32 v[54:55], v[14:15], v[48:49], v[174:175] op_sel:[1,0,0] op_sel_hi:[1,1,1]
    v_pk_fma_f32 v[48:49], v[12:13], v[48:49], v[52:53] op_sel:[1,0,0] op_sel_hi:[1,1,1]
    v_pk_fma_f32 v[50:51], v[12:13], v[50:51], v[54:55] op_sel:[1,0,0] op_sel_hi:[1,1,1]
    v_pk_fma_f32 v[52:53], v[14:15], v[50:51], v[180:181] op_sel:[1,0,0] op_sel_hi:[1,1,1] neg_lo:[1,0,0] neg_hi:[1,0,0]
    v_pk_fma_f32 v[54:55], v[14:15], v[48:49], v[188:189] op_sel:[1,0,0] op_sel_hi:[1,1,1]
    v_pk_fma_f32 v[48:49], v[12:13], v[48:49], v[52:53] op_sel:[1,0,0] op_sel_hi:[1,1,1]
    v_pk_fma_f32 v[50:51], v[12:13], v[50:51], v[54:55] op_sel:[1,0,0] op_sel_hi:[1,1,1]
    v_pk_fma_f32 v[52:53], v[14:15], v[50:51], v[182:183] op_sel:[1,0,0] op_sel_hi:[1,1,1] neg_lo:[1,0,0] neg_hi:[1,0,0]
    v_pk_fma_f32 v[54:55], v[14:15], v[48:49], v[190:191] op_sel:[1,0,0] op_sel_hi:[1,1,1]
    v_pk_fma_f32 v[48:49], v[12:13], v[48:49], v[52:53] op_sel:[1,0,0] op_sel_hi:[1,1,1]
    v_pk_fma_f32 v[50:51], v[12:13], v[50:51], v[54:55] op_sel:[1,0,0] op_sel_hi:[1,1,1]
    v_pk_fma_f32 v[52:53], v[14:15], v[50:51], v[196:197] op_sel:[1,0,0] op_sel_hi:[1,1,1] neg_lo:[1,0,0] neg_hi:[1,0,0]
    v_pk_fma_f32 v[54:55], v[14:15], v[48:49], v[204:205] op_sel:[1,0,0] op_sel_hi:[1,1,1]
    v_pk_fma_f32 v[48:49], v[12:13], v[48:49], v[52:53] op_sel:[1,0,0] op_sel_hi:[1,1,1]
    v_pk_fma_f32 v[50:51], v[12:13], v[50:51], v[54:55] op_sel:[1,0,0] op_sel_hi:[1,1,1]
    v_pk_fma_f32 v[52:53], v[14:15], v[50:51], v[198:199] op_sel:[1,0,0] op_sel_hi:[1,1,1] neg_lo:[1,0,0] neg_hi:[1,0,0]
    v_pk_fma_f32 v[54:55], v[14:15], v[48:49], v[206:207] op_sel:[1,0,0] op_sel_hi:[1,1,1]
    v_pk_fma_f32 v[48:49], v[12:13], v[48:49], v[52:53] op_sel:[1,0,0] op_sel_hi:[1,1,1]
    v_pk_fma_f32 v[50:51], v[12:13], v[50:51], v[54:55] op_sel:[1,0,0] op_sel_hi:[1,1,1]
    v_pk_fma_f32 v[52:53], v[14:15], v[50:51], v[212:213] op_sel:[1,0,0] op_sel_hi:[1,1,1] neg_lo:[1,0,0] neg_hi:[1,0,0]
    v_pk_fma_f32 v[54:55], v[14:15], v[48:49], v[220:221] op_sel:[1,0,0] op_sel_hi:[1,1,1]
    v_pk_fma_f32 v[48:49], v[12:13], v[48:49], v[52:53] op_sel:[1,0,0] op_sel_hi:[1,1,1]
    v_pk_fma_f32 v[50:51], v[12:13], v[50:51], v[54:55] op_sel:[1,0,0] op_sel_hi:[1,1,1]
    v_pk_fma_f32 v[52:53], v[14:15], v[50:51], v[214:215] op_sel:[1,0,0] op_sel_hi:[1,1,1] neg_lo:[1,0,0] neg_hi:[1,0,0]
    v_pk_fma_f32 v[54:55], v[14:15], v[48:49], v[222:223] op_sel:[1,0,0] op_sel_hi:[1,1,1]
    v_pk_fma_f32 v[48:49], v[12:13], v[48:49], v[52:53] op_sel:[1,0,0] op_sel_hi:[1,1,1]
    v_pk_fma_f32 v[50:51], v[12:13], v[50:51], v[54:55] op_sel:[1,0,0] op_sel_hi:[1,1,1]
    v_pk_fma_f32 v[52:53], v[14:15], v[50:51], v[228:229] op_sel:[1,0,0] op_sel_hi:[1,1,1] neg_lo:[1,0,0] neg_hi:[1,0,0]
    v_pk_fma_f32 v[54:55], v[14:15], v[48:49], v[236:237] op_sel:[1,0,0] op_sel_hi:[1,1,1]
    v_pk_fma_f32 v[48:49], v[12:13], v[48:49], v[52:53] op_sel:[1,0,0] op_sel_hi:[1,1,1]
    v_pk_fma_f32 v[50:51], v[12:13], v[50:51], v[54:55] op_sel:[1,0,0] op_sel_hi:[1,1,1]
    v_pk_fma_f32 v[52:53], v[14:15], v[50:51], v[230:231] op_sel:[1,0,0] op_sel_hi:[1,1,1] neg_lo:[1,0,0] neg_hi:[1,0,0]
    v_pk_fma_f32 v[54:55], v[14:15], v[48:49], v[238:239] op_sel:[1,0,0] op_sel_hi:[1,1,1]
    v_pk_fma_f32 v[48:49], v[12:13], v[48:49], v[52:53] op_sel:[1,0,0] op_sel_hi:[1,1,1]
    v_pk_fma_f32 v[50:51], v[12:13], v[50:51], v[54:55] op_sel:[1,0,0] op_sel_hi:[1,1,1]
    v_pk_fma_f32 v[52:53], v[14:15], v[50:51], v[244:245] op_sel:[1,0,0] op_sel_hi:[1,1,1] neg_lo:[1,0,0] neg_hi:[1,0,0]
    v_pk_fma_f32 v[54:55], v[14:15], v[48:49], v[252:253] op_sel:[1,0,0] op_sel_hi:[1,1,1]
    v_pk_fma_f32 v[48:49], v[12:13], v[48:49], v[52:53] op_sel:[1,0,0] op_sel_hi:[1,1,1]
    v_pk_fma_f32 v[50:51], v[12:13], v[50:51], v[54:55] op_sel:[1,0,0] op_sel_hi:[1,1,1]
    v_pk_fma_f32 v[52:53], v[14:15], v[50:51], v[246:247] op_sel:[1,0,0] op_sel_hi:[1,1,1] neg_lo:[1,0,0] neg_hi:[1,0,0]
    v_pk_fma_f32 v[54:55], v[14:15], v[48:49], v[254:255] op_sel:[1,0,0] op_sel_hi:[1,1,1]
    v_pk_fma_f32 v[48:49], v[12:13], v[48:49], v[52:53] op_sel:[1,0,0] op_sel_hi:[1,1,1]
    v_pk_fma_f32 v[50:51], v[12:13], v[50:51], v[54:55] op_sel:[1,0,0] op_sel_hi:[1,1,1]
    v_mov_b32 v31, v48
    v_mov_b32 v3, v50
    v_fma_f32 v125, -v23, v50, v49
    v_fma_f32 v127, v23, v48, v51
    v_fmac_f32 v125, v21, v48
    v_fmac_f32 v127, v21, v50
    ds_write_b128 v28, v[124:127]
    s_waitcnt lgkmcnt(0)
    s_barrier
    ds_read_b128 v[64:67], v29 offset:0
    ds_read_b128 v[68:71], v29 offset:512
    ds_read_b128 v[72:75], v29 offset:1024
    ds_read_b128 v[76:79], v29 offset:1536
    ds_read_b128 v[80:83], v29 offset:2048
    ds_read_b128 v[84:87], v29 offset:2560
    ds_read_b128 v[88:91], v29 offset:3072
    ds_read_b128 v[92:95], v29 offset:3584
    v_and_b32 v28, 0x9ff, v28
    ds_read_b128 v[32:35], v28 offset:0
    ds_read_b128 v[36:39], v28 offset:512
    ds_read_b128 v[40:43], v28 offset:1024
    s_lshl_b32 s85, s81, 13
    v_lshl_add_u32 v63, v0, 4, s85
    v_add_u32 v62, 0x1000, v63
    s_waitcnt lgkmcnt(0)
    s_bitcmp0_b32 s38, 0
    s_cbranch_scc1 L_tw0_44
    s_lshl_b32 s77, s68, 13
    s_add_u32 s77, s77, s65
    v_mov_b32 v124, v64
    v_mov_b32 v125, v65
    v_mov_b32 v126, v66
    v_mov_b32 v127, v67
    v_fma_f32 v52, -v6, v126, v68
    v_fma_f32 v53, -v7, v127, v69
    v_fma_f32 v54, v6, v124, v70
    v_fma_f32 v55, v7, v125, v71
    v_fma_f32 v124, v4, v124, v52
    v_fma_f32 v125, v5, v125, v53
    v_fma_f32 v126, v4, v126, v54
    v_fma_f32 v127, v5, v127, v55
    v_fma_f32 v52, -v6, v126, v72
    v_fma_f32 v53, -v7, v127, v73
    v_fma_f32 v54, v6, v124, v74
    v_fma_f32 v55, v7, v125, v75
    v_fma_f32 v124, v4, v124, v52
    v_fma_f32 v125, v5, v125, v53
    v_fma_f32 v126, v4, v126, v54
    v_fma_f32 v127, v5, v127, v55
    v_fma_f32 v52, -v6, v126, v76
    v_fma_f32 v53, -v7, v127, v77
    v_fma_f32 v54, v6, v124, v78
    v_fma_f32 v55, v7, v125, v79
    v_fma_f32 v124, v4, v124, v52
    v_fma_f32 v125, v5, v125, v53
    v_fma_f32 v126, v4, v126, v54
    v_fma_f32 v127, v5, v127, v55
    v_fma_f32 v52, -v6, v126, v80
    v_fma_f32 v53, -v7, v127, v81
    v_fma_f32 v54, v6, v124, v82
    v_fma_f32 v55, v7, v125, v83
    v_fma_f32 v124, v4, v124, v52
    v_fma_f32 v125, v5, v125, v53
    v_fma_f32 v126, v4, v126, v54
    v_fma_f32 v127, v5, v127, v55
    v_fma_f32 v52, -v6, v126, v84
    v_fma_f32 v53, -v7, v127, v85
    v_fma_f32 v54, v6, v124, v86
    v_fma_f32 v55, v7, v125, v87
    v_fma_f32 v124, v4, v124, v52
    v_fma_f32 v125, v5, v125, v53
    v_fma_f32 v126, v4, v126, v54
    v_fma_f32 v127, v5, v127, v55
    v_fma_f32 v52, -v6, v126, v88
    v_fma_f32 v53, -v7, v127, v89
    v_fma_f32 v54, v6, v124, v90
    v_fma_f32 v55, v7, v125, v91
    v_fma_f32 v124, v4, v124, v52
    v_fma_f32 v125, v5, v125, v53
    v_fma_f32 v126, v4, v126, v54
    v_fma_f32 v127, v5, v127, v55
    v_fma_f32 v52, -v6, v126, v92
    v_fma_f32 v53, -v7, v127, v93
    v_fma_f32 v54, v6, v124, v94
    v_fma_f32 v55, v7, v125, v95
    v_fma_f32 v124, v4, v124, v52
    v_fma_f32 v125, v5, v125, v53
    v_fma_f32 v126, v4, v126, v54
    v_fma_f32 v127, v5, v127, v55
    s_mov_b64 exec, 0xffff
    buffer_store_dwordx4 v[124:127], v29, s[40:43], s77 offen sc1
    s_mov_b64 exec, -1
L_tw0_44:
    s_mov_b32 s80, 98304
    s_add_u32 m0, s85, 98304
    s_nop 0
    buffer_load_dwordx4 v63, s[40:43], s80 offen offset:0 sc1 lds
    buffer_load_dwordx4 v63, s[40:43], s80 offen offset:1024 sc1 lds
    buffer_load_dwordx4 v63, s[40:43], s80 offen offset:2048 sc1 lds
    buffer_load_dwordx4 v63, s[40:43], s80 offen offset:3072 sc1 lds
    s_add_u32 m0, s85, 102400
    s_nop 0
    buffer_load_dwordx4 v62, s[40:43], s80 offen offset:0 sc1 lds
    buffer_load_dwordx4 v62, s[40:43], s80 offen offset:1024 sc1 lds
    buffer_load_dwordx4 v62, s[40:43], s80 offen offset:2048 sc1 lds
    buffer_load_dwordx4 v62, s[40:43], s80 offen offset:3072 sc1 lds
    s_and_b32 s77, s81, 1
    s_lshl1_add_u32 s77, s68, s77
    s_lshl_b32 s77, s77, 5
    s_add_u32 s77, s77, s69
    s_and_b32 s78, s81, 2
    s_lshl2_add_u32 s77, s77, s78
    s_lshl_b32 s77, s77, 12
    s_add_u32 s71, s77, 8388608
    s_add_u32 s72, s71, 0x40000
    v_lshlrev_b32 v8, 4, v0
    v_xor_b32 v9, 64, v8
    v_add_u32 v10, 0x1000, v8
    v_add_u32 v11, 0x1000, v9
    s_waitcnt vmcnt(0)
    s_bitcmp0_b32 s38, 0
    s_cbranch_scc1 L_tw0_45
    s_lshl2_add_u32 s77, s68, s64
    v_mov_b32 v1, 1
    s_mov_b64 exec, 1
    buffer_store_dword v1, off, s[40:43], s77 sc1
    s_mov_b64 exec, -1
L_tw0_45:
    s_barrier
    v_and_b32 v44, 7, v0
    v_lshlrev_b32 v44, 2, v44
    buffer_load_dword v45, v44, s[40:43], s64 offen sc1
    s_mov_b32 s80, 131072
    s_add_u32 m0, s85, 65536
    s_nop 0
    buffer_load_dwordx4 v63, s[40:43], s80 offen offset:0 sc1 lds
    buffer_load_dwordx4 v63, s[40:43], s80 offen offset:1024 sc1 lds
    buffer_load_dwordx4 v63, s[40:43], s80 offen offset:2048 sc1 lds
    buffer_load_dwordx4 v63, s[40:43], s80 offen offset:3072 sc1 lds
    s_add_u32 m0, s85, 69632
    s_nop 0
    buffer_load_dwordx4 v62, s[40:43], s80 offen offset:0 sc1 lds
    buffer_load_dwordx4 v62, s[40:43], s80 offen offset:1024 sc1 lds
    buffer_load_dwordx4 v62, s[40:43], s80 offen offset:2048 sc1 lds
    buffer_load_dwordx4 v62, s[40:43], s80 offen offset:3072 sc1 lds
    s_waitcnt vmcnt(8)
    v_cmp_ne_u32 vcc, 1, v45
    s_bfm_b64 s[100:101], s68, 0
    s_and_b64 vcc, vcc, s[100:101]
    s_cbranch_scc1 L_spin_46
L_spinr_47:
    s_cmp_le_u32 s68, 0
    s_cbranch_scc1 L_ldone_48
    s_add_u32 s77, s65, 0
    buffer_load_dwordx4 v[96:99], v29, s[40:43], s77 offen sc1
    s_cmp_le_u32 s68, 1
    s_cbranch_scc1 L_ldone_48
    s_add_u32 s77, s65, 8192
    buffer_load_dwordx4 v[100:103], v29, s[40:43], s77 offen sc1
    s_cmp_le_u32 s68, 2
    s_cbranch_scc1 L_ldone_48
    s_add_u32 s77, s65, 16384
    buffer_load_dwordx4 v[104:107], v29, s[40:43], s77 offen sc1
    s_cmp_le_u32 s68, 3
    s_cbranch_scc1 L_ldone_48
    s_add_u32 s77, s65, 24576
    buffer_load_dwordx4 v[108:111], v29, s[40:43], s77 offen sc1
    s_cmp_le_u32 s68, 4
    s_cbranch_scc1 L_ldone_48
    s_add_u32 s77, s65, 32768
    buffer_load_dwordx4 v[112:115], v29, s[40:43], s77 offen sc1
    s_cmp_le_u32 s68, 5
    s_cbranch_scc1 L_ldone_48
    s_add_u32 s77, s65, 40960
    buffer_load_dwordx4 v[116:119], v29, s[40:43], s77 offen sc1
    s_cmp_le_u32 s68, 6
    s_cbranch_scc1 L_ldone_48
    s_add_u32 s77, s65, 49152
    buffer_load_dwordx4 v[120:123], v29, s[40:43], s77 offen sc1
L_ldone_48:
    v_mov_b32 v124, 0
    v_mov_b32 v125, 0
    v_mov_b32 v126, 0
    v_mov_b32 v127, 0
    s_waitcnt vmcnt(0)
    s_cmp_le_u32 s68, 0
    s_cbranch_scc1 L_cdone_49
    v_pk_fma_f32 v[52:53], v[26:27], v[126:127], v[96:97] neg_lo:[1,0,0] neg_hi:[1,0,0]
    v_pk_fma_f32 v[54:55], v[26:27], v[124:125], v[98:99]
    v_pk_fma_f32 v[124:125], v[24:25], v[124:125], v[52:53]
    v_pk_fma_f32 v[126:127], v[24:25], v[126:127], v[54:55]
    s_cmp_le_u32 s68, 1
    s_cbranch_scc1 L_cdone_49
    v_pk_fma_f32 v[52:53], v[26:27], v[126:127], v[100:101] neg_lo:[1,0,0] neg_hi:[1,0,0]
    v_pk_fma_f32 v[54:55], v[26:27], v[124:125], v[102:103]
    v_pk_fma_f32 v[124:125], v[24:25], v[124:125], v[52:53]
    v_pk_fma_f32 v[126:127], v[24:25], v[126:127], v[54:55]
    s_cmp_le_u32 s68, 2
    s_cbranch_scc1 L_cdone_49
    v_pk_fma_f32 v[52:53], v[26:27], v[126:127], v[104:105] neg_lo:[1,0,0] neg_hi:[1,0,0]
    v_pk_fma_f32 v[54:55], v[26:27], v[124:125], v[106:107]
    v_pk_fma_f32 v[124:125], v[24:25], v[124:125], v[52:53]
    v_pk_fma_f32 v[126:127], v[24:25], v[126:127], v[54:55]
    s_cmp_le_u32 s68, 3
    s_cbranch_scc1 L_cdone_49
    v_pk_fma_f32 v[52:53], v[26:27], v[126:127], v[108:109] neg_lo:[1,0,0] neg_hi:[1,0,0]
    v_pk_fma_f32 v[54:55], v[26:27], v[124:125], v[110:111]
    v_pk_fma_f32 v[124:125], v[24:25], v[124:125], v[52:53]
    v_pk_fma_f32 v[126:127], v[24:25], v[126:127], v[54:55]
    s_cmp_le_u32 s68, 4
    s_cbranch_scc1 L_cdone_49
    v_pk_fma_f32 v[52:53], v[26:27], v[126:127], v[112:113] neg_lo:[1,0,0] neg_hi:[1,0,0]
    v_pk_fma_f32 v[54:55], v[26:27], v[124:125], v[114:115]
    v_pk_fma_f32 v[124:125], v[24:25], v[124:125], v[52:53]
    v_pk_fma_f32 v[126:127], v[24:25], v[126:127], v[54:55]
    s_cmp_le_u32 s68, 5
    s_cbranch_scc1 L_cdone_49
    v_pk_fma_f32 v[52:53], v[26:27], v[126:127], v[116:117] neg_lo:[1,0,0] neg_hi:[1,0,0]
    v_pk_fma_f32 v[54:55], v[26:27], v[124:125], v[118:119]
    v_pk_fma_f32 v[124:125], v[24:25], v[124:125], v[52:53]
    v_pk_fma_f32 v[126:127], v[24:25], v[126:127], v[54:55]
    s_cmp_le_u32 s68, 6
    s_cbranch_scc1 L_cdone_49
    v_pk_fma_f32 v[52:53], v[26:27], v[126:127], v[120:121] neg_lo:[1,0,0] neg_hi:[1,0,0]
    v_pk_fma_f32 v[54:55], v[26:27], v[124:125], v[122:123]
    v_pk_fma_f32 v[124:125], v[24:25], v[124:125], v[52:53]
    v_pk_fma_f32 v[126:127], v[24:25], v[126:127], v[54:55]
L_cdone_49:
    s_bitcmp0_b32 s38, 0
    s_cbranch_scc1 L_tw0_50
    v_pk_fma_f32 v[52:53], v[6:7], v[126:127], v[64:65] neg_lo:[1,0,0] neg_hi:[1,0,0]
    v_pk_fma_f32 v[54:55], v[6:7], v[124:125], v[66:67]
    v_pk_fma_f32 v[124:125], v[4:5], v[124:125], v[52:53]
    v_pk_fma_f32 v[126:127], v[4:5], v[126:127], v[54:55]
    v_pk_fma_f32 v[52:53], v[6:7], v[126:127], v[68:69] neg_lo:[1,0,0] neg_hi:[1,0,0]
    v_pk_fma_f32 v[54:55], v[6:7], v[124:125], v[70:71]
    v_pk_fma_f32 v[124:125], v[4:5], v[124:125], v[52:53]
    v_pk_fma_f32 v[126:127], v[4:5], v[126:127], v[54:55]
    v_pk_fma_f32 v[52:53], v[6:7], v[126:127], v[72:73] neg_lo:[1,0,0] neg_hi:[1,0,0]
    v_pk_fma_f32 v[54:55], v[6:7], v[124:125], v[74:75]
    v_pk_fma_f32 v[124:125], v[4:5], v[124:125], v[52:53]
    v_pk_fma_f32 v[126:127], v[4:5], v[126:127], v[54:55]
    v_pk_fma_f32 v[52:53], v[6:7], v[126:127], v[76:77] neg_lo:[1,0,0] neg_hi:[1,0,0]
    v_pk_fma_f32 v[54:55], v[6:7], v[124:125], v[78:79]
    v_pk_fma_f32 v[124:125], v[4:5], v[124:125], v[52:53]
    v_pk_fma_f32 v[126:127], v[4:5], v[126:127], v[54:55]
L_tw0_50:
    s_lshl_b64 exec, -1, 16
    v_pk_fma_f32 v[52:53], v[6:7], v[126:127], v[32:33] neg_lo:[1,0,0] neg_hi:[1,0,0]
    v_pk_fma_f32 v[54:55], v[6:7], v[124:125], v[34:35]
    v_pk_fma_f32 v[124:125], v[4:5], v[124:125], v[52:53]
    v_pk_fma_f32 v[126:127], v[4:5], v[126:127], v[54:55]
    s_lshl_b64 exec, -1, 32
    v_pk_fma_f32 v[52:53], v[6:7], v[126:127], v[36:37] neg_lo:[1,0,0] neg_hi:[1,0,0]
    v_pk_fma_f32 v[54:55], v[6:7], v[124:125], v[38:39]
    v_pk_fma_f32 v[124:125], v[4:5], v[124:125], v[52:53]
    v_pk_fma_f32 v[126:127], v[4:5], v[126:127], v[54:55]
    s_lshl_b64 exec, -1, 48
    v_pk_fma_f32 v[52:53], v[6:7], v[126:127], v[40:41] neg_lo:[1,0,0] neg_hi:[1,0,0]
    v_pk_fma_f32 v[54:55], v[6:7], v[124:125], v[42:43]
    v_pk_fma_f32 v[124:125], v[4:5], v[124:125], v[52:53]
    v_pk_fma_f32 v[126:127], v[4:5], v[126:127], v[54:55]
    s_mov_b64 exec, -1
    v_mov_b32 v48, v124
    v_mov_b32 v50, v126
    v_fma_f32 v49, -v22, v50, v30
    v_fma_f32 v51, v22, v48, v2
    v_fmac_f32 v49, v20, v48
    v_fmac_f32 v51, v20, v50
    v_mov_b32 v56, v125
    v_mov_b32 v58, v127
    v_fma_f32 v57, -v23, v58, v31
    v_fma_f32 v59, v23, v56, v3
    v_fmac_f32 v57, v21, v56
    v_fmac_f32 v59, v21, v58
    v_pk_fma_f32 v[52:53], v[14:15], v[50:51], v[128:129] op_sel:[0,0,0] op_sel_hi:[0,1,1] neg_lo:[1,0,0] neg_hi:[1,0,0]
    v_pk_fma_f32 v[54:55], v[14:15], v[48:49], v[136:137] op_sel:[0,0,0] op_sel_hi:[0,1,1]
    v_pk_fma_f32 v[48:49], v[12:13], v[48:49], v[52:53] op_sel:[0,0,0] op_sel_hi:[0,1,1]
    v_pk_fma_f32 v[50:51], v[12:13], v[50:51], v[54:55] op_sel:[0,0,0] op_sel_hi:[0,1,1]
    v_pk_mul_f32 v[136:137], v[18:19], v[48:49] op_sel:[0,0] op_sel_hi:[0,1]
    v_pk_mul_f32 v[128:129], v[18:19], v[50:51] op_sel:[0,0] op_sel_hi:[0,1]
    v_pk_fma_f32 v[136:137], v[16:17], v[50:51], v[136:137] op_sel:[0,0,0] op_sel_hi:[0,1,1] neg_lo:[1,0,1] neg_hi:[1,0,1]
    v_pk_fma_f32 v[128:129], v[16:17], v[48:49], v[128:129] op_sel:[0,0,0] op_sel_hi:[0,1,1] neg_lo:[0,0,1] neg_hi:[0,0,1]
    v_pk_fma_f32 v[52:53], v[14:15], v[50:51], v[130:131] op_sel:[0,0,0] op_sel_hi:[0,1,1] neg_lo:[1,0,0] neg_hi:[1,0,0]
    v_pk_fma_f32 v[54:55], v[14:15], v[48:49], v[138:139] op_sel:[0,0,0] op_sel_hi:[0,1,1]
    v_pk_fma_f32 v[48:49], v[12:13], v[48:49], v[52:53] op_sel:[0,0,0] op_sel_hi:[0,1,1]
    v_pk_fma_f32 v[50:51], v[12:13], v[50:51], v[54:55] op_sel:[0,0,0] op_sel_hi:[0,1,1]
    v_pk_mul_f32 v[138:139], v[18:19], v[48:49] op_sel:[0,0] op_sel_hi:[0,1]
    v_pk_mul_f32 v[130:131], v[18:19], v[50:51] op_sel:[0,0] op_sel_hi:[0,1]
    v_pk_fma_f32 v[138:139], v[16:17], v[50:51], v[138:139] op_sel:[0,0,0] op_sel_hi:[0,1,1] neg_lo:[1,0,1] neg_hi:[1,0,1]
    v_pk_fma_f32 v[130:131], v[16:17], v[48:49], v[130:131] op_sel:[0,0,0] op_sel_hi:[0,1,1] neg_lo:[0,0,1] neg_hi:[0,0,1]
    v_pk_fma_f32 v[52:53], v[14:15], v[50:51], v[144:145] op_sel:[0,0,0] op_sel_hi:[0,1,1] neg_lo:[1,0,0] neg_hi:[1,0,0]
    v_pk_fma_f32 v[54:55], v[14:15], v[48:49], v[152:153] op_sel:[0,0,0] op_sel_hi:[0,1,1]
    v_pk_fma_f32 v[48:49], v[12:13], v[48:49], v[52:53] op_sel:[0,0,0] op_sel_hi:[0,1,1]
    v_pk_fma_f32 v[50:51], v[12:13], v[50:51], v[54:55] op_sel:[0,0,0] op_sel_hi:[0,1,1]
    v_pk_mul_f32 v[152:153], v[18:19], v[48:49] op_sel:[0,0] op_sel_hi:[0,1]
    v_pk_mul_f32 v[144:145], v[18:19], v[50:51] op_sel:[0,0] op_sel_hi:[0,1]
    v_pk_fma_f32 v[152:153], v[16:17], v[50:51], v[152:153] op_sel:[0,0,0] op_sel_hi:[0,1,1] neg_lo:[1,0,1] neg_hi:[1,0,1]
    v_pk_fma_f32 v[144:145], v[16:17], v[48:49], v[144:145] op_sel:[0,0,0] op_sel_hi:[0,1,1] neg_lo:[0,0,1] neg_hi:[0,0,1]
    v_pk_fma_f32 v[52:53], v[14:15], v[50:51], v[146:147] op_sel:[0,0,0] op_sel_hi:[0,1,1] neg_lo:[1,0,0] neg_hi:[1,0,0]
    v_pk_fma_f32 v[54:55], v[14:15], v[48:49], v[154:155] op_sel:[0,0,0] op_sel_hi:[0,1,1]
    v_pk_fma_f32 v[48:49], v[12:13], v[48:49], v[52:53] op_sel:[0,0,0] op_sel_hi:[0,1,1]
    v_pk_fma_f32 v[50:51], v[12:13], v[50:51], v[54:55] op_sel:[0,0,0] op_sel_hi:[0,1,1]
    v_pk_mul_f32 v[154:155], v[18:19], v[48:49] op_sel:[0,0] op_sel_hi:[0,1]
    v_pk_mul_f32 v[146:147], v[18:19], v[50:51] op_sel:[0,0] op_sel_hi:[0,1]
    v_pk_fma_f32 v[154:155], v[16:17], v[50:51], v[154:155] op_sel:[0,0,0] op_sel_hi:[0,1,1] neg_lo:[1,0,1] neg_hi:[1,0,1]
    v_pk_fma_f32 v[146:147], v[16:17], v[48:49], v[146:147] op_sel:[0,0,0] op_sel_hi:[0,1,1] neg_lo:[0,0,1] neg_hi:[0,0,1]
    v_pk_fma_f32 v[52:53], v[14:15], v[50:51], v[160:161] op_sel:[0,0,0] op_sel_hi:[0,1,1] neg_lo:[1,0,0] neg_hi:[1,0,0]
    v_pk_fma_f32 v[54:55], v[14:15], v[48:49], v[168:169] op_sel:[0,0,0] op_sel_hi:[0,1,1]
    v_pk_fma_f32 v[48:49], v[12:13], v[48:49], v[52:53] op_sel:[0,0,0] op_sel_hi:[0,1,1]
    v_pk_fma_f32 v[50:51], v[12:13], v[50:51], v[54:55] op_sel:[0,0,0] op_sel_hi:[0,1,1]
    v_pk_mul_f32 v[168:169], v[18:19], v[48:49] op_sel:[0,0] op_sel_hi:[0,1]
    v_pk_mul_f32 v[160:161], v[18:19], v[50:51] op_sel:[0,0] op_sel_hi:[0,1]
    v_pk_fma_f32 v[168:169], v[16:17], v[50:51], v[168:169] op_sel:[0,0,0] op_sel_hi:[0,1,1] neg_lo:[1,0,1] neg_hi:[1,0,1]
    v_pk_fma_f32 v[160:161], v[16:17], v[48:49], v[160:161] op_sel:[0,0,0] op_sel_hi:[0,1,1] neg_lo:[0,0,1] neg_hi:[0,0,1]
    v_pk_fma_f32 v[52:53], v[14:15], v[50:51], v[162:163] op_sel:[0,0,0] op_sel_hi:[0,1,1] neg_lo:[1,0,0] neg_hi:[1,0,0]
    v_pk_fma_f32 v[54:55], v[14:15], v[48:49], v[170:171] op_sel:[0,0,0] op_sel_hi:[0,1,1]
    v_pk_fma_f32 v[48:49], v[12:13], v[48:49], v[52:53] op_sel:[0,0,0] op_sel_hi:[0,1,1]
    v_pk_fma_f32 v[50:51], v[12:13], v[50:51], v[54:55] op_sel:[0,0,0] op_sel_hi:[0,1,1]
    v_pk_mul_f32 v[170:171], v[18:19], v[48:49] op_sel:[0,0] op_sel_hi:[0,1]
    v_pk_mul_f32 v[162:163], v[18:19], v[50:51] op_sel:[0,0] op_sel_hi:[0,1]
    v_pk_fma_f32 v[170:171], v[16:17], v[50:51], v[170:171] op_sel:[0,0,0] op_sel_hi:[0,1,1] neg_lo:[1,0,1] neg_hi:[1,0,1]
    v_pk_fma_f32 v[162:163], v[16:17], v[48:49], v[162:163] op_sel:[0,0,0] op_sel_hi:[0,1,1] neg_lo:[0,0,1] neg_hi:[0,0,1]
    v_pk_fma_f32 v[52:53], v[14:15], v[50:51], v[176:177] op_sel:[0,0,0] op_sel_hi:[0,1,1] neg_lo:[1,0,0] neg_hi:[1,0,0]
    v_pk_fma_f32 v[54:55], v[14:15], v[48:49], v[184:185] op_sel:[0,0,0] op_sel_hi:[0,1,1]
    v_pk_fma_f32 v[48:49], v[12:13], v[48:49], v[52:53] op_sel:[0,0,0] op_sel_hi:[0,1,1]
    v_pk_fma_f32 v[50:51], v[12:13], v[50:51], v[54:55] op_sel:[0,0,0] op_sel_hi:[0,1,1]
    v_pk_mul_f32 v[184:185], v[18:19], v[48:49] op_sel:[0,0] op_sel_hi:[0,1]
    v_pk_mul_f32 v[176:177], v[18:19], v[50:51] op_sel:[0,0] op_sel_hi:[0,1]
    v_pk_fma_f32 v[184:185], v[16:17], v[50:51], v[184:185] op_sel:[0,0,0] op_sel_hi:[0,1,1] neg_lo:[1,0,1] neg_hi:[1,0,1]
    v_pk_fma_f32 v[176:177], v[16:17], v[48:49], v[176:177] op_sel:[0,0,0] op_sel_hi:[0,1,1] neg_lo:[0,0,1] neg_hi:[0,0,1]
    v_pk_fma_f32 v[52:53], v[14:15], v[50:51], v[178:179] op_sel:[0,0,0] op_sel_hi:[0,1,1] neg_lo:[1,0,0] neg_hi:[1,0,0]
    v_pk_fma_f32 v[54:55], v[14:15], v[48:49], v[186:187] op_sel:[0,0,0] op_sel_hi:[0,1,1]
    v_pk_fma_f32 v[48:49], v[12:13], v[48:49], v[52:53] op_sel:[0,0,0] op_sel_hi:[0,1,1]
    v_pk_fma_f32 v[50:51], v[12:13], v[50:51], v[54:55] op_sel:[0,0,0] op_sel_hi:[0,1,1]
    v_pk_mul_f32 v[186:187], v[18:19], v[48:49] op_sel:[0,0] op_sel_hi:[0,1]
    v_pk_mul_f32 v[178:179], v[18:19], v[50:51] op_sel:[0,0] op_sel_hi:[0,1]
    v_pk_fma_f32 v[186:187], v[16:17], v[50:51], v[186:187] op_sel:[0,0,0] op_sel_hi:[0,1,1] neg_lo:[1,0,1] neg_hi:[1,0,1]
    v_pk_fma_f32 v[178:179], v[16:17], v[48:49], v[178:179] op_sel:[0,0,0] op_sel_hi:[0,1,1] neg_lo:[0,0,1] neg_hi:[0,0,1]
    v_pk_fma_f32 v[52:53], v[14:15], v[50:51], v[192:193] op_sel:[0,0,0] op_sel_hi:[0,1,1] neg_lo:[1,0,0] neg_hi:[1,0,0]
    v_pk_fma_f32 v[54:55], v[14:15], v[48:49], v[200:201] op_sel:[0,0,0] op_sel_hi:[0,1,1]
    v_pk_fma_f32 v[48:49], v[12:13], v[48:49], v[52:53] op_sel:[0,0,0] op_sel_hi:[0,1,1]
    v_pk_fma_f32 v[50:51], v[12:13], v[50:51], v[54:55] op_sel:[0,0,0] op_sel_hi:[0,1,1]
    v_pk_mul_f32 v[200:201], v[18:19], v[48:49] op_sel:[0,0] op_sel_hi:[0,1]
    v_pk_mul_f32 v[192:193], v[18:19], v[50:51] op_sel:[0,0] op_sel_hi:[0,1]
    v_pk_fma_f32 v[200:201], v[16:17], v[50:51], v[200:201] op_sel:[0,0,0] op_sel_hi:[0,1,1] neg_lo:[1,0,1] neg_hi:[1,0,1]
    v_pk_fma_f32 v[192:193], v[16:17], v[48:49], v[192:193] op_sel:[0,0,0] op_sel_hi:[0,1,1] neg_lo:[0,0,1] neg_hi:[0,0,1]
    v_pk_fma_f32 v[52:53], v[14:15], v[50:51], v[194:195] op_sel:[0,0,0] op_sel_hi:[0,1,1] neg_lo:[1,0,0] neg_hi:[1,0,0]
    v_pk_fma_f32 v[54:55], v[14:15], v[48:49], v[202:203] op_sel:[0,0,0] op_sel_hi:[0,1,1]
    v_pk_fma_f32 v[48:49], v[12:13], v[48:49], v[52:53] op_sel:[0,0,0] op_sel_hi:[0,1,1]
    v_pk_fma_f32 v[50:51], v[12:13], v[50:51], v[54:55] op_sel:[0,0,0] op_sel_hi:[0,1,1]
    v_pk_mul_f32 v[202:203], v[18:19], v[48:49] op_sel:[0,0] op_sel_hi:[0,1]
    v_pk_mul_f32 v[194:195], v[18:19], v[50:51] op_sel:[0,0] op_sel_hi:[0,1]
    v_pk_fma_f32 v[202:203], v[16:17], v[50:51], v[202:203] op_sel:[0,0,0] op_sel_hi:[0,1,1] neg_lo:[1,0,1] neg_hi:[1,0,1]
    v_pk_fma_f32 v[194:195], v[16:17], v[48:49], v[194:195] op_sel:[0,0,0] op_sel_hi:[0,1,1] neg_lo:[0,0,1] neg_hi:[0,0,1]
    v_pk_fma_f32 v[52:53], v[14:15], v[50:51], v[208:209] op_sel:[0,0,0] op_sel_hi:[0,1,1] neg_lo:[1,0,0] neg_hi:[1,0,0]
    v_pk_fma_f32 v[54:55], v[14:15], v[48:49], v[216:217] op_sel:[0,0,0] op_sel_hi:[0,1,1]
    v_pk_fma_f32 v[48:49], v[12:13], v[48:49], v[52:53] op_sel:[0,0,0] op_sel_hi:[0,1,1]
    v_pk_fma_f32 v[50:51], v[12:13], v[50:51], v[54:55] op_sel:[0,0,0] op_sel_hi:[0,1,1]
    v_pk_mul_f32 v[216:217], v[18:19], v[48:49] op_sel:[0,0] op_sel_hi:[0,1]
    v_pk_mul_f32 v[208:209], v[18:19], v[50:51] op_sel:[0,0] op_sel_hi:[0,1]
    v_pk_fma_f32 v[216:217], v[16:17], v[50:51], v[216:217] op_sel:[0,0,0] op_sel_hi:[0,1,1] neg_lo:[1,0,1] neg_hi:[1,0,1]
    v_pk_fma_f32 v[208:209], v[16:17], v[48:49], v[208:209] op_sel:[0,0,0] op_sel_hi:[0,1,1] neg_lo:[0,0,1] neg_hi:[0,0,1]
    v_pk_fma_f32 v[52:53], v[14:15], v[50:51], v[210:211] op_sel:[0,0,0] op_sel_hi:[0,1,1] neg_lo:[1,0,0] neg_hi:[1,0,0]
    v_pk_fma_f32 v[54:55], v[14:15], v[48:49], v[218:219] op_sel:[0,0,0] op_sel_hi:[0,1,1]
    v_pk_fma_f32 v[48:49], v[12:13], v[48:49], v[52:53] op_sel:[0,0,0] op_sel_hi:[0,1,1]
    v_pk_fma_f32 v[50:51], v[12:13], v[50:51], v[54:55] op_sel:[0,0,0] op_sel_hi:[0,1,1]
    v_pk_mul_f32 v[218:219], v[18:19], v[48:49] op_sel:[0,0] op_sel_hi:[0,1]
    v_pk_mul_f32 v[210:211], v[18:19], v[50:51] op_sel:[0,0] op_sel_hi:[0,1]
    v_pk_fma_f32 v[218:219], v[16:17], v[50:51], v[218:219] op_sel:[0,0,0] op_sel_hi:[0,1,1] neg_lo:[1,0,1] neg_hi:[1,0,1]
    v_pk_fma_f32 v[210:211], v[16:17], v[48:49], v[210:211] op_sel:[0,0,0] op_sel_hi:[0,1,1] neg_lo:[0,0,1] neg_hi:[0,0,1]
    v_pk_fma_f32 v[52:53], v[14:15], v[50:51], v[224:225] op_sel:[0,0,0] op_sel_hi:[0,1,1] neg_lo:[1,0,0] neg_hi:[1,0,0]
    v_pk_fma_f32 v[54:55], v[14:15], v[48:49], v[232:233] op_sel:[0,0,0] op_sel_hi:[0,1,1]
    v_pk_fma_f32 v[48:49], v[12:13], v[48:49], v[52:53] op_sel:[0,0,0] op_sel_hi:[0,1,1]
    v_pk_fma_f32 v[50:51], v[12:13], v[50:51], v[54:55] op_sel:[0,0,0] op_sel_hi:[0,1,1]
    v_pk_mul_f32 v[232:233], v[18:19], v[48:49] op_sel:[0,0] op_sel_hi:[0,1]
    v_pk_mul_f32 v[224:225], v[18:19], v[50:51] op_sel:[0,0] op_sel_hi:[0,1]
    v_pk_fma_f32 v[232:233], v[16:17], v[50:51], v[232:233] op_sel:[0,0,0] op_sel_hi:[0,1,1] neg_lo:[1,0,1] neg_hi:[1,0,1]
    v_pk_fma_f32 v[224:225], v[16:17], v[48:49], v[224:225] op_sel:[0,0,0] op_sel_hi:[0,1,1] neg_lo:[0,0,1] neg_hi:[0,0,1]
    v_pk_fma_f32 v[52:53], v[14:15], v[50:51], v[226:227] op_sel:[0,0,0] op_sel_hi:[0,1,1] neg_lo:[1,0,0] neg_hi:[1,0,0]
    v_pk_fma_f32 v[54:55], v[14:15], v[48:49], v[234:235] op_sel:[0,0,0] op_sel_hi:[0,1,1]
    v_pk_fma_f32 v[48:49], v[12:13], v[48:49], v[52:53] op_sel:[0,0,0] op_sel_hi:[0,1,1]
    v_pk_fma_f32 v[50:51], v[12:13], v[50:51], v[54:55] op_sel:[0,0,0] op_sel_hi:[0,1,1]
    v_pk_mul_f32 v[234:235], v[18:19], v[48:49] op_sel:[0,0] op_sel_hi:[0,1]
    v_pk_mul_f32 v[226:227], v[18:19], v[50:51] op_sel:[0,0] op_sel_hi:[0,1]
    v_pk_fma_f32 v[234:235], v[16:17], v[50:51], v[234:235] op_sel:[0,0,0] op_sel_hi:[0,1,1] neg_lo:[1,0,1] neg_hi:[1,0,1]
    v_pk_fma_f32 v[226:227], v[16:17], v[48:49], v[226:227] op_sel:[0,0,0] op_sel_hi:[0,1,1] neg_lo:[0,0,1] neg_hi:[0,0,1]
    v_pk_fma_f32 v[52:53], v[14:15], v[50:51], v[240:241] op_sel:[0,0,0] op_sel_hi:[0,1,1] neg_lo:[1,0,0] neg_hi:[1,0,0]
    v_pk_fma_f32 v[54:55], v[14:15], v[48:49], v[248:249] op_sel:[0,0,0] op_sel_hi:[0,1,1]
    v_pk_fma_f32 v[48:49], v[12:13], v[48:49], v[52:53] op_sel:[0,0,0] op_sel_hi:[0,1,1]
    v_pk_fma_f32 v[50:51], v[12:13], v[50:51], v[54:55] op_sel:[0,0,0] op_sel_hi:[0,1,1]
    v_pk_mul_f32 v[248:249], v[18:19], v[48:49] op_sel:[0,0] op_sel_hi:[0,1]
    v_pk_mul_f32 v[240:241], v[18:19], v[50:51] op_sel:[0,0] op_sel_hi:[0,1]
    v_pk_fma_f32 v[248:249], v[16:17], v[50:51], v[248:249] op_sel:[0,0,0] op_sel_hi:[0,1,1] neg_lo:[1,0,1] neg_hi:[1,0,1]
    v_pk_fma_f32 v[240:241], v[16:17], v[48:49], v[240:241] op_sel:[0,0,0] op_sel_hi:[0,1,1] neg_lo:[0,0,1] neg_hi:[0,0,1]
    v_pk_fma_f32 v[52:53], v[14:15], v[50:51], v[242:243] op_sel:[0,0,0] op_sel_hi:[0,1,1] neg_lo:[1,0,0] neg_hi:[1,0,0]
    v_pk_fma_f32 v[54:55], v[14:15], v[48:49], v[250:251] op_sel:[0,0,0] op_sel_hi:[0,1,1]
    v_pk_fma_f32 v[48:49], v[12:13], v[48:49], v[52:53] op_sel:[0,0,0] op_sel_hi:[0,1,1]
    v_pk_fma_f32 v[50:51], v[12:13], v[50:51], v[54:55] op_sel:[0,0,0] op_sel_hi:[0,1,1]
    v_pk_mul_f32 v[250:251], v[18:19], v[48:49] op_sel:[0,0] op_sel_hi:[0,1]
    v_pk_mul_f32 v[242:243], v[18:19], v[50:51] op_sel:[0,0] op_sel_hi:[0,1]
    v_pk_fma_f32 v[250:251], v[16:17], v[50:51], v[250:251] op_sel:[0,0,0] op_sel_hi:[0,1,1] neg_lo:[1,0,1] neg_hi:[1,0,1]
    v_pk_fma_f32 v[242:243], v[16:17], v[48:49], v[242:243] op_sel:[0,0,0] op_sel_hi:[0,1,1] neg_lo:[0,0,1] neg_hi:[0,0,1]
    v_pk_fma_f32 v[52:53], v[14:15], v[58:59], v[132:133] op_sel:[1,0,0] op_sel_hi:[1,1,1] neg_lo:[1,0,0] neg_hi:[1,0,0]
    v_pk_fma_f32 v[54:55], v[14:15], v[56:57], v[140:141] op_sel:[1,0,0] op_sel_hi:[1,1,1]
    v_pk_fma_f32 v[56:57], v[12:13], v[56:57], v[52:53] op_sel:[1,0,0] op_sel_hi:[1,1,1]
    v_pk_fma_f32 v[58:59], v[12:13], v[58:59], v[54:55] op_sel:[1,0,0] op_sel_hi:[1,1,1]
    v_pk_mul_f32 v[140:141], v[18:19], v[56:57] op_sel:[1,0] op_sel_hi:[1,1]
    v_pk_mul_f32 v[132:133], v[18:19], v[58:59] op_sel:[1,0] op_sel_hi:[1,1]
    v_pk_fma_f32 v[140:141], v[16:17], v[58:59], v[140:141] op_sel:[1,0,0] op_sel_hi:[1,1,1] neg_lo:[1,0,1] neg_hi:[1,0,1]
    v_pk_fma_f32 v[132:133], v[16:17], v[56:57], v[132:133] op_sel:[1,0,0] op_sel_hi:[1,1,1] neg_lo:[0,0,1] neg_hi:[0,0,1]
    v_pk_fma_f32 v[52:53], v[14:15], v[58:59], v[134:135] op_sel:[1,0,0] op_sel_hi:[1,1,1] neg_lo:[1,0,0] neg_hi:[1,0,0]
    v_pk_fma_f32 v[54:55], v[14:15], v[56:57], v[142:143] op_sel:[1,0,0] op_sel_hi:[1,1,1]
    v_pk_fma_f32 v[56:57], v[12:13], v[56:57], v[52:53] op_sel:[1,0,0] op_sel_hi:[1,1,1]
    v_pk_fma_f32 v[58:59], v[12:13], v[58:59], v[54:55] op_sel:[1,0,0] op_sel_hi:[1,1,1]
    v_pk_mul_f32 v[142:143], v[18:19], v[56:57] op_sel:[1,0] op_sel_hi:[1,1]
    v_pk_mul_f32 v[134:135], v[18:19], v[58:59] op_sel:[1,0] op_sel_hi:[1,1]
    v_pk_fma_f32 v[142:143], v[16:17], v[58:59], v[142:143] op_sel:[1,0,0] op_sel_hi:[1,1,1] neg_lo:[1,0,1] neg_hi:[1,0,1]
    v_pk_fma_f32 v[134:135], v[16:17], v[56:57], v[134:135] op_sel:[1,0,0] op_sel_hi:[1,1,1] neg_lo:[0,0,1] neg_hi:[0,0,1]
    v_pk_fma_f32 v[52:53], v[14:15], v[58:59], v[148:149] op_sel:[1,0,0] op_sel_hi:[1,1,1] neg_lo:[1,0,0] neg_hi:[1,0,0]
    v_pk_fma_f32 v[54:55], v[14:15], v[56:57], v[156:157] op_sel:[1,0,0] op_sel_hi:[1,1,1]
    v_pk_fma_f32 v[56:57], v[12:13], v[56:57], v[52:53] op_sel:[1,0,0] op_sel_hi:[1,1,1]
    v_pk_fma_f32 v[58:59], v[12:13], v[58:59], v[54:55] op_sel:[1,0,0] op_sel_hi:[1,1,1]
    v_pk_mul_f32 v[156:157], v[18:19], v[56:57] op_sel:[1,0] op_sel_hi:[1,1]
    v_pk_mul_f32 v[148:149], v[18:19], v[58:59] op_sel:[1,0] op_sel_hi:[1,1]
    v_pk_fma_f32 v[156:157], v[16:17], v[58:59], v[156:157] op_sel:[1,0,0] op_sel_hi:[1,1,1] neg_lo:[1,0,1] neg_hi:[1,0,1]
    v_pk_fma_f32 v[148:149], v[16:17], v[56:57], v[148:149] op_sel:[1,0,0] op_sel_hi:[1,1,1] neg_lo:[0,0,1] neg_hi:[0,0,1]
    v_pk_fma_f32 v[52:53], v[14:15], v[58:59], v[150:151] op_sel:[1,0,0] op_sel_hi:[1,1,1] neg_lo:[1,0,0] neg_hi:[1,0,0]
    v_pk_fma_f32 v[54:55], v[14:15], v[56:57], v[158:159] op_sel:[1,0,0] op_sel_hi:[1,1,1]
    v_pk_fma_f32 v[56:57], v[12:13], v[56:57], v[52:53] op_sel:[1,0,0] op_sel_hi:[1,1,1]
    v_pk_fma_f32 v[58:59], v[12:13], v[58:59], v[54:55] op_sel:[1,0,0] op_sel_hi:[1,1,1]
    v_pk_mul_f32 v[158:159], v[18:19], v[56:57] op_sel:[1,0] op_sel_hi:[1,1]
    v_pk_mul_f32 v[150:151], v[18:19], v[58:59] op_sel:[1,0] op_sel_hi:[1,1]
    v_pk_fma_f32 v[158:159], v[16:17], v[58:59], v[158:159] op_sel:[1,0,0] op_sel_hi:[1,1,1] neg_lo:[1,0,1] neg_hi:[1,0,1]
    v_pk_fma_f32 v[150:151], v[16:17], v[56:57], v[150:151] op_sel:[1,0,0] op_sel_hi:[1,1,1] neg_lo:[0,0,1] neg_hi:[0,0,1]
    v_pk_fma_f32 v[52:53], v[14:15], v[58:59], v[164:165] op_sel:[1,0,0] op_sel_hi:[1,1,1] neg_lo:[1,0,0] neg_hi:[1,0,0]
    v_pk_fma_f32 v[54:55], v[14:15], v[56:57], v[172:173] op_sel:[1,0,0] op_sel_hi:[1,1,1]
    v_pk_fma_f32 v[56:57], v[12:13], v[56:57], v[52:53] op_sel:[1,0,0] op_sel_hi:[1,1,1]
    v_pk_fma_f32 v[58:59], v[12:13], v[58:59], v[54:55] op_sel:[1,0,0] op_sel_hi:[1,1,1]
    v_pk_mul_f32 v[172:173], v[18:19], v[56:57] op_sel:[1,0] op_sel_hi:[1,1]
    v_pk_mul_f32 v[164:165], v[18:19], v[58:59] op_sel:[1,0] op_sel_hi:[1,1]
    v_pk_fma_f32 v[172:173], v[16:17], v[58:59], v[172:173] op_sel:[1,0,0] op_sel_hi:[1,1,1] neg_lo:[1,0,1] neg_hi:[1,0,1]
    v_pk_fma_f32 v[164:165], v[16:17], v[56:57], v[164:165] op_sel:[1,0,0] op_sel_hi:[1,1,1] neg_lo:[0,0,1] neg_hi:[0,0,1]
    v_pk_fma_f32 v[52:53], v[14:15], v[58:59], v[166:167] op_sel:[1,0,0] op_sel_hi:[1,1,1] neg_lo:[1,0,0] neg_hi:[1,0,0]
    v_pk_fma_f32 v[54:55], v[14:15], v[56:57], v[174:175] op_sel:[1,0,0] op_sel_hi:[1,1,1]
    v_pk_fma_f32 v[56:57], v[12:13], v[56:57], v[52:53] op_sel:[1,0,0] op_sel_hi:[1,1,1]
    v_pk_fma_f32 v[58:59], v[12:13], v[58:59], v[54:55] op_sel:[1,0,0] op_sel_hi:[1,1,1]
    v_pk_mul_f32 v[174:175], v[18:19], v[56:57] op_sel:[1,0] op_sel_hi:[1,1]
    v_pk_mul_f32 v[166:167], v[18:19], v[58:59] op_sel:[1,0] op_sel_hi:[1,1]
    v_pk_fma_f32 v[174:175], v[16:17], v[58:59], v[174:175] op_sel:[1,0,0] op_sel_hi:[1,1,1] neg_lo:[1,0,1] neg_hi:[1,0,1]
    v_pk_fma_f32 v[166:167], v[16:17], v[56:57], v[166:167] op_sel:[1,0,0] op_sel_hi:[1,1,1] neg_lo:[0,0,1] neg_hi:[0,0,1]
    v_pk_fma_f32 v[52:53], v[14:15], v[58:59], v[180:181] op_sel:[1,0,0] op_sel_hi:[1,1,1] neg_lo:[1,0,0] neg_hi:[1,0,0]
    v_pk_fma_f32 v[54:55], v[14:15], v[56:57], v[188:189] op_sel:[1,0,0] op_sel_hi:[1,1,1]
    v_pk_fma_f32 v[56:57], v[12:13], v[56:57], v[52:53] op_sel:[1,0,0] op_sel_hi:[1,1,1]
    v_pk_fma_f32 v[58:59], v[12:13], v[58:59], v[54:55] op_sel:[1,0,0] op_sel_hi:[1,1,1]
    v_pk_mul_f32 v[188:189], v[18:19], v[56:57] op_sel:[1,0] op_sel_hi:[1,1]
    v_pk_mul_f32 v[180:181], v[18:19], v[58:59] op_sel:[1,0] op_sel_hi:[1,1]
    v_pk_fma_f32 v[188:189], v[16:17], v[58:59], v[188:189] op_sel:[1,0,0] op_sel_hi:[1,1,1] neg_lo:[1,0,1] neg_hi:[1,0,1]
    v_pk_fma_f32 v[180:181], v[16:17], v[56:57], v[180:181] op_sel:[1,0,0] op_sel_hi:[1,1,1] neg_lo:[0,0,1] neg_hi:[0,0,1]
    v_pk_fma_f32 v[52:53], v[14:15], v[58:59], v[182:183] op_sel:[1,0,0] op_sel_hi:[1,1,1] neg_lo:[1,0,0] neg_hi:[1,0,0]
    v_pk_fma_f32 v[54:55], v[14:15], v[56:57], v[190:191] op_sel:[1,0,0] op_sel_hi:[1,1,1]
    v_pk_fma_f32 v[56:57], v[12:13], v[56:57], v[52:53] op_sel:[1,0,0] op_sel_hi:[1,1,1]
    v_pk_fma_f32 v[58:59], v[12:13], v[58:59], v[54:55] op_sel:[1,0,0] op_sel_hi:[1,1,1]
    v_pk_mul_f32 v[190:191], v[18:19], v[56:57] op_sel:[1,0] op_sel_hi:[1,1]
    v_pk_mul_f32 v[182:183], v[18:19], v[58:59] op_sel:[1,0] op_sel_hi:[1,1]
    v_pk_fma_f32 v[190:191], v[16:17], v[58:59], v[190:191] op_sel:[1,0,0] op_sel_hi:[1,1,1] neg_lo:[1,0,1] neg_hi:[1,0,1]
    v_pk_fma_f32 v[182:183], v[16:17], v[56:57], v[182:183] op_sel:[1,0,0] op_sel_hi:[1,1,1] neg_lo:[0,0,1] neg_hi:[0,0,1]
    v_pk_fma_f32 v[52:53], v[14:15], v[58:59], v[196:197] op_sel:[1,0,0] op_sel_hi:[1,1,1] neg_lo:[1,0,0] neg_hi:[1,0,0]
    v_pk_fma_f32 v[54:55], v[14:15], v[56:57], v[204:205] op_sel:[1,0,0] op_sel_hi:[1,1,1]
    v_pk_fma_f32 v[56:57], v[12:13], v[56:57], v[52:53] op_sel:[1,0,0] op_sel_hi:[1,1,1]
    v_pk_fma_f32 v[58:59], v[12:13], v[58:59], v[54:55] op_sel:[1,0,0] op_sel_hi:[1,1,1]
    v_pk_mul_f32 v[204:205], v[18:19], v[56:57] op_sel:[1,0] op_sel_hi:[1,1]
    v_pk_mul_f32 v[196:197], v[18:19], v[58:59] op_sel:[1,0] op_sel_hi:[1,1]
    v_pk_fma_f32 v[204:205], v[16:17], v[58:59], v[204:205] op_sel:[1,0,0] op_sel_hi:[1,1,1] neg_lo:[1,0,1] neg_hi:[1,0,1]
    v_pk_fma_f32 v[196:197], v[16:17], v[56:57], v[196:197] op_sel:[1,0,0] op_sel_hi:[1,1,1] neg_lo:[0,0,1] neg_hi:[0,0,1]
    v_pk_fma_f32 v[52:53], v[14:15], v[58:59], v[198:199] op_sel:[1,0,0] op_sel_hi:[1,1,1] neg_lo:[1,0,0] neg_hi:[1,0,0]
    v_pk_fma_f32 v[54:55], v[14:15], v[56:57], v[206:207] op_sel:[1,0,0] op_sel_hi:[1,1,1]
    v_pk_fma_f32 v[56:57], v[12:13], v[56:57], v[52:53] op_sel:[1,0,0] op_sel_hi:[1,1,1]
    v_pk_fma_f32 v[58:59], v[12:13], v[58:59], v[54:55] op_sel:[1,0,0] op_sel_hi:[1,1,1]
    v_pk_mul_f32 v[206:207], v[18:19], v[56:57] op_sel:[1,0] op_sel_hi:[1,1]
    v_pk_mul_f32 v[198:199], v[18:19], v[58:59] op_sel:[1,0] op_sel_hi:[1,1]
    v_pk_fma_f32 v[206:207], v[16:17], v[58:59], v[206:207] op_sel:[1,0,0] op_sel_hi:[1,1,1] neg_lo:[1,0,1] neg_hi:[1,0,1]
    v_pk_fma_f32 v[198:199], v[16:17], v[56:57], v[198:199] op_sel:[1,0,0] op_sel_hi:[1,1,1] neg_lo:[0,0,1] neg_hi:[0,0,1]
    v_pk_fma_f32 v[52:53], v[14:15], v[58:59], v[212:213] op_sel:[1,0,0] op_sel_hi:[1,1,1] neg_lo:[1,0,0] neg_hi:[1,0,0]
    v_pk_fma_f32 v[54:55], v[14:15], v[56:57], v[220:221] op_sel:[1,0,0] op_sel_hi:[1,1,1]
    v_pk_fma_f32 v[56:57], v[12:13], v[56:57], v[52:53] op_sel:[1,0,0] op_sel_hi:[1,1,1]
    v_pk_fma_f32 v[58:59], v[12:13], v[58:59], v[54:55] op_sel:[1,0,0] op_sel_hi:[1,1,1]
    v_pk_mul_f32 v[220:221], v[18:19], v[56:57] op_sel:[1,0] op_sel_hi:[1,1]
    v_pk_mul_f32 v[212:213], v[18:19], v[58:59] op_sel:[1,0] op_sel_hi:[1,1]
    v_pk_fma_f32 v[220:221], v[16:17], v[58:59], v[220:221] op_sel:[1,0,0] op_sel_hi:[1,1,1] neg_lo:[1,0,1] neg_hi:[1,0,1]
    v_pk_fma_f32 v[212:213], v[16:17], v[56:57], v[212:213] op_sel:[1,0,0] op_sel_hi:[1,1,1] neg_lo:[0,0,1] neg_hi:[0,0,1]
    v_pk_fma_f32 v[52:53], v[14:15], v[58:59], v[214:215] op_sel:[1,0,0] op_sel_hi:[1,1,1] neg_lo:[1,0,0] neg_hi:[1,0,0]
    v_pk_fma_f32 v[54:55], v[14:15], v[56:57], v[222:223] op_sel:[1,0,0] op_sel_hi:[1,1,1]
    v_pk_fma_f32 v[56:57], v[12:13], v[56:57], v[52:53] op_sel:[1,0,0] op_sel_hi:[1,1,1]
    v_pk_fma_f32 v[58:59], v[12:13], v[58:59], v[54:55] op_sel:[1,0,0] op_sel_hi:[1,1,1]
    v_pk_mul_f32 v[222:223], v[18:19], v[56:57] op_sel:[1,0] op_sel_hi:[1,1]
    v_pk_mul_f32 v[214:215], v[18:19], v[58:59] op_sel:[1,0] op_sel_hi:[1,1]
    v_pk_fma_f32 v[222:223], v[16:17], v[58:59], v[222:223] op_sel:[1,0,0] op_sel_hi:[1,1,1] neg_lo:[1,0,1] neg_hi:[1,0,1]
    v_pk_fma_f32 v[214:215], v[16:17], v[56:57], v[214:215] op_sel:[1,0,0] op_sel_hi:[1,1,1] neg_lo:[0,0,1] neg_hi:[0,0,1]
    v_pk_fma_f32 v[52:53], v[14:15], v[58:59], v[228:229] op_sel:[1,0,0] op_sel_hi:[1,1,1] neg_lo:[1,0,0] neg_hi:[1,0,0]
    v_pk_fma_f32 v[54:55], v[14:15], v[56:57], v[236:237] op_sel:[1,0,0] op_sel_hi:[1,1,1]
    v_pk_fma_f32 v[56:57], v[12:13], v[56:57], v[52:53] op_sel:[1,0,0] op_sel_hi:[1,1,1]
    v_pk_fma_f32 v[58:59], v[12:13], v[58:59], v[54:55] op_sel:[1,0,0] op_sel_hi:[1,1,1]
    v_pk_mul_f32 v[236:237], v[18:19], v[56:57] op_sel:[1,0] op_sel_hi:[1,1]
    v_pk_mul_f32 v[228:229], v[18:19], v[58:59] op_sel:[1,0] op_sel_hi:[1,1]
    v_pk_fma_f32 v[236:237], v[16:17], v[58:59], v[236:237] op_sel:[1,0,0] op_sel_hi:[1,1,1] neg_lo:[1,0,1] neg_hi:[1,0,1]
    v_pk_fma_f32 v[228:229], v[16:17], v[56:57], v[228:229] op_sel:[1,0,0] op_sel_hi:[1,1,1] neg_lo:[0,0,1] neg_hi:[0,0,1]
    v_pk_fma_f32 v[52:53], v[14:15], v[58:59], v[230:231] op_sel:[1,0,0] op_sel_hi:[1,1,1] neg_lo:[1,0,0] neg_hi:[1,0,0]
    v_pk_fma_f32 v[54:55], v[14:15], v[56:57], v[238:239] op_sel:[1,0,0] op_sel_hi:[1,1,1]
    v_pk_fma_f32 v[56:57], v[12:13], v[56:57], v[52:53] op_sel:[1,0,0] op_sel_hi:[1,1,1]
    v_pk_fma_f32 v[58:59], v[12:13], v[58:59], v[54:55] op_sel:[1,0,0] op_sel_hi:[1,1,1]
    v_pk_mul_f32 v[238:239], v[18:19], v[56:57] op_sel:[1,0] op_sel_hi:[1,1]
    v_pk_mul_f32 v[230:231], v[18:19], v[58:59] op_sel:[1,0] op_sel_hi:[1,1]
    v_pk_fma_f32 v[238:239], v[16:17], v[58:59], v[238:239] op_sel:[1,0,0] op_sel_hi:[1,1,1] neg_lo:[1,0,1] neg_hi:[1,0,1]
    v_pk_fma_f32 v[230:231], v[16:17], v[56:57], v[230:231] op_sel:[1,0,0] op_sel_hi:[1,1,1] neg_lo:[0,0,1] neg_hi:[0,0,1]
    v_pk_fma_f32 v[52:53], v[14:15], v[58:59], v[244:245] op_sel:[1,0,0] op_sel_hi:[1,1,1] neg_lo:[1,0,0] neg_hi:[1,0,0]
    v_pk_fma_f32 v[54:55], v[14:15], v[56:57], v[252:253] op_sel:[1,0,0] op_sel_hi:[1,1,1]
    v_pk_fma_f32 v[56:57], v[12:13], v[56:57], v[52:53] op_sel:[1,0,0] op_sel_hi:[1,1,1]
    v_pk_fma_f32 v[58:59], v[12:13], v[58:59], v[54:55] op_sel:[1,0,0] op_sel_hi:[1,1,1]
    v_pk_mul_f32 v[252:253], v[18:19], v[56:57] op_sel:[1,0] op_sel_hi:[1,1]
    v_pk_mul_f32 v[244:245], v[18:19], v[58:59] op_sel:[1,0] op_sel_hi:[1,1]
    v_pk_fma_f32 v[252:253], v[16:17], v[58:59], v[252:253] op_sel:[1,0,0] op_sel_hi:[1,1,1] neg_lo:[1,0,1] neg_hi:[1,0,1]
    v_pk_fma_f32 v[244:245], v[16:17], v[56:57], v[244:245] op_sel:[1,0,0] op_sel_hi:[1,1,1] neg_lo:[0,0,1] neg_hi:[0,0,1]
    v_pk_fma_f32 v[52:53], v[14:15], v[58:59], v[246:247] op_sel:[1,0,0] op_sel_hi:[1,1,1] neg_lo:[1,0,0] neg_hi:[1,0,0]
    v_pk_fma_f32 v[54:55], v[14:15], v[56:57], v[254:255] op_sel:[1,0,0] op_sel_hi:[1,1,1]
    v_pk_fma_f32 v[56:57], v[12:13], v[56:57], v[52:53] op_sel:[1,0,0] op_sel_hi:[1,1,1]
    v_pk_fma_f32 v[58:59], v[12:13], v[58:59], v[54:55] op_sel:[1,0,0] op_sel_hi:[1,1,1]
    v_pk_mul_f32 v[254:255], v[18:19], v[56:57] op_sel:[1,0] op_sel_hi:[1,1]
    v_pk_mul_f32 v[246:247], v[18:19], v[58:59] op_sel:[1,0] op_sel_hi:[1,1]
    v_pk_fma_f32 v[254:255], v[16:17], v[58:59], v[254:255] op_sel:[1,0,0] op_sel_hi:[1,1,1] neg_lo:[1,0,1] neg_hi:[1,0,1]
    v_pk_fma_f32 v[246:247], v[16:17], v[56:57], v[246:247] op_sel:[1,0,0] op_sel_hi:[1,1,1] neg_lo:[0,0,1] neg_hi:[0,0,1]
    s_mov_b32 s48, s30
    s_mov_b32 s49, s31
    s_mov_b32 s50, 0x200000
    s_mov_b32 s51, 0x20000
    s_barrier
    s_mov_b32 s80, 163840
    s_add_u32 m0, s85, 131072
    s_nop 0
    buffer_load_dwordx4 v63, s[40:43], s80 offen offset:0 sc1 lds
    buffer_load_dwordx4 v63, s[40:43], s80 offen offset:1024 sc1 lds
    buffer_load_dwordx4 v63, s[40:43], s80 offen offset:2048 sc1 lds
    buffer_load_dwordx4 v63, s[40:43], s80 offen offset:3072 sc1 lds
    s_add_u32 m0, s85, 135168
    s_nop 0
    buffer_load_dwordx4 v62, s[40:43], s80 offen offset:0 sc1 lds
    buffer_load_dwordx4 v62, s[40:43], s80 offen offset:1024 sc1 lds
    buffer_load_dwordx4 v62, s[40:43], s80 offen offset:2048 sc1 lds
    buffer_load_dwordx4 v62, s[40:43], s80 offen offset:3072 sc1 lds
    v_cvt_pk_bf16_f32 v128, v128, v130
    v_cvt_pk_bf16_f32 v130, v160, v162
    v_cvt_pk_bf16_f32 v160, v129, v131
    v_cvt_pk_bf16_f32 v129, v144, v146
    v_cvt_pk_bf16_f32 v131, v176, v178
    v_cvt_pk_bf16_f32 v162, v161, v163
    v_cvt_pk_bf16_f32 v161, v145, v147
    v_cvt_pk_bf16_f32 v163, v177, v179
    buffer_store_dwordx4 v[128:131], v8, s[40:43], s71 offen offset:0 sc1
    buffer_store_dwordx4 v[160:163], v8, s[40:43], s71 offen offset:2048 sc1
    v_cvt_pk_bf16_f32 v192, v192, v194
    v_cvt_pk_bf16_f32 v194, v224, v226
    v_cvt_pk_bf16_f32 v224, v193, v195
    v_cvt_pk_bf16_f32 v193, v208, v210
    v_cvt_pk_bf16_f32 v195, v240, v242
    v_cvt_pk_bf16_f32 v226, v225, v227
    v_cvt_pk_bf16_f32 v225, v209, v211
    v_cvt_pk_bf16_f32 v227, v241, v243
    buffer_store_dwordx4 v[192:195], v9, s[40:43], s71 offen offset:1024 sc1
    buffer_store_dwordx4 v[224:227], v9, s[40:43], s71 offen offset:3072 sc1
    v_cvt_pk_bf16_f32 v132, v132, v134
    v_cvt_pk_bf16_f32 v134, v164, v166
    v_cvt_pk_bf16_f32 v164, v133, v135
    v_cvt_pk_bf16_f32 v133, v148, v150
    v_cvt_pk_bf16_f32 v135, v180, v182
    v_cvt_pk_bf16_f32 v166, v165, v167
    v_cvt_pk_bf16_f32 v165, v149, v151
    v_cvt_pk_bf16_f32 v167, v181, v183
    buffer_store_dwordx4 v[132:135], v10, s[40:43], s71 offen offset:0 sc1
    buffer_store_dwordx4 v[164:167], v10, s[40:43], s71 offen offset:2048 sc1
    v_cvt_pk_bf16_f32 v196, v196, v198
    v_cvt_pk_bf16_f32 v198, v228, v230
    v_cvt_pk_bf16_f32 v228, v197, v199
    v_cvt_pk_bf16_f32 v197, v212, v214
    v_cvt_pk_bf16_f32 v199, v244, v246
    v_cvt_pk_bf16_f32 v230, v229, v231
    v_cvt_pk_bf16_f32 v229, v213, v215
    v_cvt_pk_bf16_f32 v231, v245, v247
    buffer_store_dwordx4 v[196:199], v11, s[40:43], s71 offen offset:1024 sc1
    buffer_store_dwordx4 v[228:231], v11, s[40:43], s71 offen offset:3072 sc1
    s_lshl4_add_u32 s77, s68, s69
    s_lshl2_add_u32 s77, s77, s81
    s_lshl2_add_u32 s77, s77, 2048
    s_waitcnt vmcnt(0)
    v_mov_b32 v1, 1
    s_mov_b64 exec, 1
    buffer_store_dword v1, off, s[40:43], s77 sc1
    s_mov_b64 exec, -1
    s_barrier
    s_mov_b32 s80, 196608
    s_add_u32 m0, s85, 98304
    s_nop 0
    buffer_load_dwordx4 v63, s[40:43], s80 offen offset:0 sc1 lds
    buffer_load_dwordx4 v63, s[40:43], s80 offen offset:1024 sc1 lds
    buffer_load_dwordx4 v63, s[40:43], s80 offen offset:2048 sc1 lds
    buffer_load_dwordx4 v63, s[40:43], s80 offen offset:3072 sc1 lds
    s_add_u32 m0, s85, 102400
    s_nop 0
    buffer_load_dwordx4 v62, s[40:43], s80 offen offset:0 sc1 lds
    buffer_load_dwordx4 v62, s[40:43], s80 offen offset:1024 sc1 lds
    buffer_load_dwordx4 v62, s[40:43], s80 offen offset:2048 sc1 lds
    buffer_load_dwordx4 v62, s[40:43], s80 offen offset:3072 sc1 lds
    v_cvt_pk_bf16_f32 v136, v136, v138
    v_cvt_pk_bf16_f32 v138, v168, v170
    v_cvt_pk_bf16_f32 v168, v137, v139
    v_cvt_pk_bf16_f32 v137, v152, v154
    v_cvt_pk_bf16_f32 v139, v184, v186
    v_cvt_pk_bf16_f32 v170, v169, v171
    v_cvt_pk_bf16_f32 v169, v153, v155
    v_cvt_pk_bf16_f32 v171, v185, v187
    buffer_store_dwordx4 v[136:139], v8, s[40:43], s72 offen offset:0 sc1
    buffer_store_dwordx4 v[168:171], v8, s[40:43], s72 offen offset:2048 sc1
    v_cvt_pk_bf16_f32 v200, v200, v202
    v_cvt_pk_bf16_f32 v202, v232, v234
    v_cvt_pk_bf16_f32 v232, v201, v203
    v_cvt_pk_bf16_f32 v201, v216, v218
    v_cvt_pk_bf16_f32 v203, v248, v250
    v_cvt_pk_bf16_f32 v234, v233, v235
    v_cvt_pk_bf16_f32 v233, v217, v219
    v_cvt_pk_bf16_f32 v235, v249, v251
    buffer_store_dwordx4 v[200:203], v9, s[40:43], s72 offen offset:1024 sc1
    buffer_store_dwordx4 v[232:235], v9, s[40:43], s72 offen offset:3072 sc1
    v_cvt_pk_bf16_f32 v140, v140, v142
    v_cvt_pk_bf16_f32 v142, v172, v174
    v_cvt_pk_bf16_f32 v172, v141, v143
    v_cvt_pk_bf16_f32 v141, v156, v158
    v_cvt_pk_bf16_f32 v143, v188, v190
    v_cvt_pk_bf16_f32 v174, v173, v175
    v_cvt_pk_bf16_f32 v173, v157, v159
    v_cvt_pk_bf16_f32 v175, v189, v191
    buffer_store_dwordx4 v[140:143], v10, s[40:43], s72 offen offset:0 sc1
    buffer_store_dwordx4 v[172:175], v10, s[40:43], s72 offen offset:2048 sc1
    v_cvt_pk_bf16_f32 v204, v204, v206
    v_cvt_pk_bf16_f32 v206, v236, v238
    v_cvt_pk_bf16_f32 v236, v205, v207
    v_cvt_pk_bf16_f32 v205, v220, v222
    v_cvt_pk_bf16_f32 v207, v252, v254
    v_cvt_pk_bf16_f32 v238, v237, v239
    v_cvt_pk_bf16_f32 v237, v221, v223
    v_cvt_pk_bf16_f32 v239, v253, v255
    buffer_store_dwordx4 v[204:207], v11, s[40:43], s72 offen offset:1024 sc1
    buffer_store_dwordx4 v[236:239], v11, s[40:43], s72 offen offset:3072 sc1
    s_lshl4_add_u32 s77, s68, s69
    s_lshl2_add_u32 s77, s77, s81
    s_lshl2_add_u32 s77, s77, 12288
    s_waitcnt vmcnt(0)
    v_mov_b32 v1, 1
    s_mov_b64 exec, 1
    buffer_store_dword v1, off, s[40:43], s77 sc1
    s_mov_b64 exec, -1
    s_lshl2_add_u32 s77, s83, s81
    s_lshl_b32 s77, s77, 12
    v_and_b32 v1, 31, v0
    v_lshlrev_b32 v1, 7, v1
    buffer_load_dword v7, v1, s[48:51], s77 offen
    s_barrier
    s_mov_b32 s80, 229376
    s_add_u32 m0, s85, 65536
    s_nop 0
    buffer_load_dwordx4 v63, s[40:43], s80 offen offset:0 sc1 lds
    buffer_load_dwordx4 v63, s[40:43], s80 offen offset:1024 sc1 lds
    buffer_load_dwordx4 v63, s[40:43], s80 offen offset:2048 sc1 lds
    buffer_load_dwordx4 v63, s[40:43], s80 offen offset:3072 sc1 lds
    s_add_u32 m0, s85, 69632
    s_nop 0
    buffer_load_dwordx4 v62, s[40:43], s80 offen offset:0 sc1 lds
    buffer_load_dwordx4 v62, s[40:43], s80 offen offset:1024 sc1 lds
    buffer_load_dwordx4 v62, s[40:43], s80 offen offset:2048 sc1 lds
    buffer_load_dwordx4 v62, s[40:43], s80 offen offset:3072 sc1 lds
    s_mov_b32 s48, s30
    s_mov_b32 s49, s31
    s_mov_b32 s50, 0x200000
    s_mov_b32 s51, 0x20000
    s_lshl_b32 s77, s81, 12
    v_lshl_add_u32 v52, v0, 4, s77
    s_lshl_b32 s78, s3, 8
    v_lshrrev_b32 v1, 4, v0
    v_and_b32 v2, 15, v0
    v_lshlrev_b32 v3, 1, v1
    v_xor_b32 v2, v2, v3
    s_lshl_b32 s77, s81, 4
    v_add_lshl_u32 v1, v1, s77, 11
    v_lshl_add_u32 v1, v2, 4, v1
    v_add_u32 v53, s78, v1
    v_xor_b32 v1, 0x80, v53
    v_add_u32 v54, 7168, v53
    v_add_u32 v55, 14336, v1
    v_add_u32 v56, 21504, v1
    s_lshl_b32 s73, s81, 12
    s_add_u32 s74, s73, 16384
    s_mov_b32 s75, 0
    s_lshl_b32 s82, s3, 0
    s_add_u32 s82, s82, 0
    s_lshl_b32 s82, s82, 1
    s_and_b32 s82, s82, 15
    s_lshl_b32 s86, s39, 18
    s_add_u32 s86, s86, 4194304
    s_and_b32 s78, s81, 1
    s_lshl_b32 s78, s78, 2
    v_mov_b32 v28, 0
    v_mov_b32 v29, 0
    v_mov_b32 v30, 0
    v_mov_b32 v31, 0
    v_bfe_u32 v1, v0, 2, 2
    v_lshrrev_b32 v2, 4, v0
    v_lshl_add_u32 v2, v2, 3, v1
    v_bfe_u32 v1, v0, 2, 3
    v_xor_b32 v1, s78, v1
    v_lshlrev_b32 v1, 5, v1
    v_lshl_add_u32 v2, v2, 8, v1
    v_and_b32 v3, 3, v0
    v_lshl_add_u32 v40, v3, 3, v2
    v_xor_b32 v41, 32, v40
    v_xor_b32 v42, 64, v40
    v_xor_b32 v43, 96, v40
    s_lshr_b32 s78, s81, 1
    s_lshl_b32 s78, s78, 13
    s_add_u32 s78, s78, 16384
    v_lshl_add_u32 v44, v0, 4, s78
    s_lshr_b32 s78, s81, 1
    s_lshl1_add_u32 s77, s39, s78
    s_lshl_b32 s77, s77, 19
    s_and_b32 s78, s81, 1
    s_lshl1_add_u32 s78, s3, s78
    s_lshl_b32 s78, s78, 8
    s_add_u32 s77, s77, s78
    s_add_u32 s64, s77, 4096
    s_add_u32 s65, s77, 135168
    s_add_u32 s66, s77, 266240
    s_add_u32 s67, s77, 397312
    s_lshl_b32 s77, s81, 13
    s_add_u32 s77, s77, 131072
    v_and_b32 v46, 15, v0
    v_and_b32 v1, 48, v0
    v_mul_u32_u24 v32, 272, v46
    v_add3_u32 v32, v32, v1, s77
    v_lshlrev_b32 v46, 4, v46
    v_mul_u32_u24 v33, 17, v1
    v_add3_u32 v33, v33, v46, s77
    v_lshl_add_u32 v46, v1, 9, v46
    v_mfma_f32_32x32x16_bf16 v[192:207], v[28:31], v[28:31], 0
    v_mfma_f32_32x32x16_bf16 v[208:223], v[28:31], v[28:31], 0
    v_mfma_f32_32x32x16_bf16 v[224:239], v[28:31], v[28:31], 0
    v_mfma_f32_32x32x16_bf16 v[240:255], v[28:31], v[28:31], 0
    s_lshl2_add_u32 s77, s83, s81
    s_lshl_b32 s77, s77, 12
    s_add_u32 s77, s77, 524288
    v_and_b32 v1, 31, v0
    v_lshlrev_b32 v1, 7, v1
    buffer_load_dword v7, v1, s[48:51], s77 offen
    s_waitcnt vmcnt(1)
    s_barrier
    s_mov_b32 s80, 262144
    s_add_u32 m0, s85, 131072
    s_nop 0
    buffer_load_dwordx4 v63, s[40:43], s80 offen offset:0 sc1 lds
    buffer_load_dwordx4 v63, s[40:43], s80 offen offset:1024 sc1 lds
    buffer_load_dwordx4 v63, s[40:43], s80 offen offset:2048 sc1 lds
    buffer_load_dwordx4 v63, s[40:43], s80 offen offset:3072 sc1 lds
    s_add_u32 m0, s85, 135168
    s_nop 0
    buffer_load_dwordx4 v62, s[40:43], s80 offen offset:0 sc1 lds
    buffer_load_dwordx4 v62, s[40:43], s80 offen offset:1024 sc1 lds
    buffer_load_dwordx4 v62, s[40:43], s80 offen offset:2048 sc1 lds
    buffer_load_dwordx4 v62, s[40:43], s80 offen offset:3072 sc1 lds
    s_lshl2_add_u32 s77, s83, s81
    s_lshl_b32 s77, s77, 12
    s_add_u32 s77, s77, 1048576
    v_and_b32 v1, 31, v0
    v_lshlrev_b32 v1, 7, v1
    buffer_load_dword v7, v1, s[48:51], s77 offen
    s_waitcnt vmcnt(1)
    s_barrier
    s_mov_b32 s80, 294912
    s_add_u32 m0, s85, 98304
    s_nop 0
    buffer_load_dwordx4 v63, s[40:43], s80 offen offset:0 sc1 lds
    buffer_load_dwordx4 v63, s[40:43], s80 offen offset:1024 sc1 lds
    buffer_load_dwordx4 v63, s[40:43], s80 offen offset:2048 sc1 lds
    buffer_load_dwordx4 v63, s[40:43], s80 offen offset:3072 sc1 lds
    s_add_u32 m0, s85, 102400
    s_nop 0
    buffer_load_dwordx4 v62, s[40:43], s80 offen offset:0 sc1 lds
    buffer_load_dwordx4 v62, s[40:43], s80 offen offset:1024 sc1 lds
    buffer_load_dwordx4 v62, s[40:43], s80 offen offset:2048 sc1 lds
    buffer_load_dwordx4 v62, s[40:43], s80 offen offset:3072 sc1 lds
    s_lshl2_add_u32 s77, s83, s81
    s_lshl_b32 s77, s77, 12
    s_add_u32 s77, s77, 1572864
    v_and_b32 v1, 31, v0
    v_lshlrev_b32 v1, 7, v1
    buffer_load_dword v7, v1, s[48:51], s77 offen
    s_waitcnt vmcnt(1)
    s_barrier
    s_lshl_b32 s77, s39, 8
    s_add_u32 s77, s77, 4096
    v_min_u32 v48, 31, v0
    v_lshlrev_b32 v48, 2, v48
    buffer_load_dword v49, v48, s[40:43], s77 offen sc1
    s_waitcnt vmcnt(0)
    v_cmp_ne_u32 vcc, 1, v49
    s_mov_b64 s[100:101], -1
    s_and_b64 vcc, vcc, s[100:101]
    s_cbranch_scc1 L_spin_51
L_spinr_52:
L_pre_53:
    s_lshl_b32 s72, s82, 17
    s_lshl_b32 s71, s82, 14
    s_add_u32 s71, s71, s86
    s_add_u32 m0, s75, s73
    s_nop 0
    buffer_load_dwordx4 v53, s[48:51], s72 offen offset:0 lds
    buffer_load_dwordx4 v54, s[48:51], s72 offen offset:1024 lds
    buffer_load_dwordx4 v55, s[48:51], s72 offen offset:2048 lds
    buffer_load_dwordx4 v56, s[48:51], s72 offen offset:3072 lds
    s_add_u32 m0, s75, s74
    s_nop 0
    buffer_load_dwordx4 v52, s[40:43], s71 offen offset:0 sc1 lds
    buffer_load_dwordx4 v52, s[40:43], s71 offen offset:1024 sc1 lds
    buffer_load_dwordx4 v52, s[40:43], s71 offen offset:2048 sc1 lds
    buffer_load_dwordx4 v52, s[40:43], s71 offen offset:3072 sc1 lds
    s_add_u32 s82, s82, 2
    s_and_b32 s82, s82, 15
    s_add_u32 s75, s75, 0x8000
    s_and_b32 s75, s75, 0x1ffff
    s_cmp_lg_u32 s75, 0x18000
    s_cbranch_scc1 L_pre_53
    s_setprio 0
    s_waitcnt vmcnt(0)
    s_barrier
    ds_read_b64_tr_b16 v[64:65], v40 offset:0
    ds_read_b64_tr_b16 v[66:67], v40 offset:1024
    ds_read_b64_tr_b16 v[68:69], v40 offset:8192
    ds_read_b64_tr_b16 v[70:71], v40 offset:9216
    ds_read_b128 v[96:99], v44 offset:0
    ds_read_b128 v[100:103], v44 offset:1024
    ds_read_b128 v[104:107], v44 offset:2048
    ds_read_b128 v[108:111], v44 offset:3072
    ds_read_b128 v[112:115], v44 offset:4096
    ds_read_b128 v[116:119], v44 offset:5120
    ds_read_b128 v[120:123], v44 offset:6144
    ds_read_b128 v[124:127], v44 offset:7168
    ds_read_b64_tr_b16 v[72:73], v41 offset:0
    ds_read_b64_tr_b16 v[74:75], v41 offset:1024
    ds_read_b64_tr_b16 v[76:77], v41 offset:8192
    ds_read_b64_tr_b16 v[78:79], v41 offset:9216
    ds_read_b64_tr_b16 v[80:81], v42 offset:0
    ds_read_b64_tr_b16 v[82:83], v42 offset:1024
    ds_read_b64_tr_b16 v[84:85], v42 offset:8192
    ds_read_b64_tr_b16 v[86:87], v42 offset:9216
    ds_read_b64_tr_b16 v[88:89], v43 offset:0
    ds_read_b64_tr_b16 v[90:91], v43 offset:1024
    ds_read_b64_tr_b16 v[92:93], v43 offset:8192
    ds_read_b64_tr_b16 v[94:95], v43 offset:9216
    s_mov_b32 s70, 0
    .p2align 3
L_gloop_54:
    s_waitcnt lgkmcnt(0)
    v_mfma_f32_16x16x32_bf16 v[192:195], v[64:67], v[96:99], v[192:195]
    s_barrier
    v_mfma_f32_16x16x32_bf16 v[192:195], v[68:71], v[100:103], v[192:195]
    ds_read_b64_tr_b16 v[128:129], v40 offset:32768
    v_mfma_f32_16x16x32_bf16 v[196:199], v[64:67], v[104:107], v[196:199]
    ds_read_b64_tr_b16 v[130:131], v40 offset:33792
    v_mfma_f32_16x16x32_bf16 v[196:199], v[68:71], v[108:111], v[196:199]
    ds_read_b64_tr_b16 v[132:133], v40 offset:40960
    v_mfma_f32_16x16x32_bf16 v[200:203], v[64:67], v[112:115], v[200:203]
    ds_read_b64_tr_b16 v[134:135], v40 offset:41984
    v_mfma_f32_16x16x32_bf16 v[200:203], v[68:71], v[116:119], v[200:203]
    ds_read_b128 v[160:163], v44 offset:32768
    v_mfma_f32_16x16x32_bf16 v[204:207], v[64:67], v[120:123], v[204:207]
    ds_read_b128 v[164:167], v44 offset:33792
    v_mfma_f32_16x16x32_bf16 v[204:207], v[68:71], v[124:127], v[204:207]
    ds_read_b128 v[168:171], v44 offset:34816
    v_mfma_f32_16x16x32_bf16 v[220:223], v[72:75], v[120:123], v[220:223]
    ds_read_b128 v[172:175], v44 offset:35840
    v_mfma_f32_16x16x32_bf16 v[220:223], v[76:79], v[124:127], v[220:223]
    ds_read_b128 v[176:179], v44 offset:36864
    v_mfma_f32_16x16x32_bf16 v[216:219], v[72:75], v[112:115], v[216:219]
    ds_read_b128 v[180:183], v44 offset:37888
    v_mfma_f32_16x16x32_bf16 v[216:219], v[76:79], v[116:119], v[216:219]
    ds_read_b128 v[184:187], v44 offset:38912
    v_mfma_f32_16x16x32_bf16 v[212:215], v[72:75], v[104:107], v[212:215]
    ds_read_b128 v[188:191], v44 offset:39936
    v_mfma_f32_16x16x32_bf16 v[212:215], v[76:79], v[108:111], v[212:215]
    ds_read_b64_tr_b16 v[136:137], v41 offset:32768
    v_mfma_f32_16x16x32_bf16 v[208:211], v[72:75], v[96:99], v[208:211]
    ds_read_b64_tr_b16 v[138:139], v41 offset:33792
    v_mfma_f32_16x16x32_bf16 v[208:211], v[76:79], v[100:103], v[208:211]
    ds_read_b64_tr_b16 v[140:141], v41 offset:40960
    v_mfma_f32_16x16x32_bf16 v[224:227], v[80:83], v[96:99], v[224:227]
    ds_read_b64_tr_b16 v[142:143], v41 offset:41984
    v_mfma_f32_16x16x32_bf16 v[224:227], v[84:87], v[100:103], v[224:227]
    ds_read_b64_tr_b16 v[144:145], v42 offset:32768
    v_mfma_f32_16x16x32_bf16 v[228:231], v[80:83], v[104:107], v[228:231]
    ds_read_b64_tr_b16 v[146:147], v42 offset:33792
    v_mfma_f32_16x16x32_bf16 v[228:231], v[84:87], v[108:111], v[228:231]
    ds_read_b64_tr_b16 v[148:149], v42 offset:40960
    v_mfma_f32_16x16x32_bf16 v[232:235], v[80:83], v[112:115], v[232:235]
    ds_read_b64_tr_b16 v[150:151], v42 offset:41984
    v_mfma_f32_16x16x32_bf16 v[232:235], v[84:87], v[116:119], v[232:235]
    ds_read_b64_tr_b16 v[152:153], v43 offset:32768
    v_mfma_f32_16x16x32_bf16 v[236:239], v[80:83], v[120:123], v[236:239]
    ds_read_b64_tr_b16 v[154:155], v43 offset:33792
    v_mfma_f32_16x16x32_bf16 v[236:239], v[84:87], v[124:127], v[236:239]
    ds_read_b64_tr_b16 v[156:157], v43 offset:40960
    v_mfma_f32_16x16x32_bf16 v[252:255], v[88:91], v[120:123], v[252:255]
    ds_read_b64_tr_b16 v[158:159], v43 offset:41984
    v_mfma_f32_16x16x32_bf16 v[252:255], v[92:95], v[124:127], v[252:255]
    v_xor_b32 v40, 0x10000, v40
    v_mfma_f32_16x16x32_bf16 v[248:251], v[88:91], v[112:115], v[248:251]
    v_xor_b32 v41, 0x10000, v41
    v_mfma_f32_16x16x32_bf16 v[248:251], v[92:95], v[116:119], v[248:251]
    v_xor_b32 v42, 0x10000, v42
    v_mfma_f32_16x16x32_bf16 v[244:247], v[88:91], v[104:107], v[244:247]
    v_xor_b32 v43, 0x10000, v43
    v_mfma_f32_16x16x32_bf16 v[244:247], v[92:95], v[108:111], v[244:247]
    v_xor_b32 v44, 0x10000, v44
    v_mfma_f32_16x16x32_bf16 v[240:243], v[88:91], v[96:99], v[240:243]
    v_mfma_f32_16x16x32_bf16 v[240:243], v[92:95], v[100:103], v[240:243]
    s_waitcnt lgkmcnt(0)
    v_mfma_f32_16x16x32_bf16 v[192:195], v[128:131], v[160:163], v[192:195]
    s_barrier
    v_mfma_f32_16x16x32_bf16 v[192:195], v[132:135], v[164:167], v[192:195]
    ds_read_b64_tr_b16 v[64:65], v40 offset:0
    v_mfma_f32_16x16x32_bf16 v[196:199], v[128:131], v[168:171], v[196:199]
    ds_read_b64_tr_b16 v[66:67], v40 offset:1024
    v_mfma_f32_16x16x32_bf16 v[196:199], v[132:135], v[172:175], v[196:199]
    ds_read_b64_tr_b16 v[68:69], v40 offset:8192
    v_mfma_f32_16x16x32_bf16 v[200:203], v[128:131], v[176:179], v[200:203]
    ds_read_b64_tr_b16 v[70:71], v40 offset:9216
    v_mfma_f32_16x16x32_bf16 v[200:203], v[132:135], v[180:183], v[200:203]
    ds_read_b128 v[96:99], v44 offset:0
    v_mfma_f32_16x16x32_bf16 v[204:207], v[128:131], v[184:187], v[204:207]
    ds_read_b128 v[100:103], v44 offset:1024
    v_mfma_f32_16x16x32_bf16 v[204:207], v[132:135], v[188:191], v[204:207]
    ds_read_b128 v[104:107], v44 offset:2048
    v_mfma_f32_16x16x32_bf16 v[220:223], v[136:139], v[184:187], v[220:223]
    ds_read_b128 v[108:111], v44 offset:3072
    v_mfma_f32_16x16x32_bf16 v[220:223], v[140:143], v[188:191], v[220:223]
    ds_read_b128 v[112:115], v44 offset:4096
    v_mfma_f32_16x16x32_bf16 v[216:219], v[136:139], v[176:179], v[216:219]
    ds_read_b128 v[116:119], v44 offset:5120
    v_mfma_f32_16x16x32_bf16 v[216:219], v[140:143], v[180:183], v[216:219]
    ds_read_b128 v[120:123], v44 offset:6144
    v_mfma_f32_16x16x32_bf16 v[212:215], v[136:139], v[168:171], v[212:215]
    ds_read_b128 v[124:127], v44 offset:7168
    v_mfma_f32_16x16x32_bf16 v[212:215], v[140:143], v[172:175], v[212:215]
    ds_read_b64_tr_b16 v[72:73], v41 offset:0
    v_mfma_f32_16x16x32_bf16 v[208:211], v[136:139], v[160:163], v[208:211]
    ds_read_b64_tr_b16 v[74:75], v41 offset:1024
    v_mfma_f32_16x16x32_bf16 v[208:211], v[140:143], v[164:167], v[208:211]
    ds_read_b64_tr_b16 v[76:77], v41 offset:8192
    v_mfma_f32_16x16x32_bf16 v[224:227], v[144:147], v[160:163], v[224:227]
    ds_read_b64_tr_b16 v[78:79], v41 offset:9216
    v_mfma_f32_16x16x32_bf16 v[224:227], v[148:151], v[164:167], v[224:227]
    ds_read_b64_tr_b16 v[80:81], v42 offset:0
    v_mfma_f32_16x16x32_bf16 v[228:231], v[144:147], v[168:171], v[228:231]
    ds_read_b64_tr_b16 v[82:83], v42 offset:1024
    v_mfma_f32_16x16x32_bf16 v[228:231], v[148:151], v[172:175], v[228:231]
    ds_read_b64_tr_b16 v[84:85], v42 offset:8192
    v_mfma_f32_16x16x32_bf16 v[232:235], v[144:147], v[176:179], v[232:235]
    ds_read_b64_tr_b16 v[86:87], v42 offset:9216
    v_mfma_f32_16x16x32_bf16 v[232:235], v[148:151], v[180:183], v[232:235]
    ds_read_b64_tr_b16 v[88:89], v43 offset:0
    v_mfma_f32_16x16x32_bf16 v[236:239], v[144:147], v[184:187], v[236:239]
    ds_read_b64_tr_b16 v[90:91], v43 offset:1024
    v_mfma_f32_16x16x32_bf16 v[236:239], v[148:151], v[188:191], v[236:239]
    ds_read_b64_tr_b16 v[92:93], v43 offset:8192
    v_mfma_f32_16x16x32_bf16 v[252:255], v[152:155], v[184:187], v[252:255]
    ds_read_b64_tr_b16 v[94:95], v43 offset:9216
    v_mfma_f32_16x16x32_bf16 v[252:255], v[156:159], v[188:191], v[252:255]
    s_add_u32 s70, s70, 1
    v_mfma_f32_16x16x32_bf16 v[248:251], v[152:155], v[176:179], v[248:251]
    s_cmp_lg_u32 s70, 7
    v_mfma_f32_16x16x32_bf16 v[248:251], v[156:159], v[180:183], v[248:251]
    v_mfma_f32_16x16x32_bf16 v[244:247], v[152:155], v[168:171], v[244:247]
    v_mfma_f32_16x16x32_bf16 v[244:247], v[156:159], v[172:175], v[244:247]
    v_mfma_f32_16x16x32_bf16 v[240:243], v[152:155], v[160:163], v[240:243]
    v_mfma_f32_16x16x32_bf16 v[240:243], v[156:159], v[164:167], v[240:243]
    s_cbranch_scc1 L_gloop_54
    s_waitcnt lgkmcnt(0)
    v_mfma_f32_16x16x32_bf16 v[192:195], v[64:67], v[96:99], v[192:195]
    s_barrier
    v_mfma_f32_16x16x32_bf16 v[192:195], v[68:71], v[100:103], v[192:195]
    ds_read_b64_tr_b16 v[128:129], v40 offset:32768
    v_mfma_f32_16x16x32_bf16 v[208:211], v[72:75], v[96:99], v[208:211]
    ds_read_b64_tr_b16 v[130:131], v40 offset:33792
    v_mfma_f32_16x16x32_bf16 v[208:211], v[76:79], v[100:103], v[208:211]
    ds_read_b64_tr_b16 v[132:133], v40 offset:40960
    v_mfma_f32_16x16x32_bf16 v[224:227], v[80:83], v[96:99], v[224:227]
    ds_read_b64_tr_b16 v[134:135], v40 offset:41984
    v_mfma_f32_16x16x32_bf16 v[224:227], v[84:87], v[100:103], v[224:227]
    ds_read_b64_tr_b16 v[136:137], v41 offset:32768
    v_mfma_f32_16x16x32_bf16 v[240:243], v[88:91], v[96:99], v[240:243]
    ds_read_b64_tr_b16 v[138:139], v41 offset:33792
    v_mfma_f32_16x16x32_bf16 v[240:243], v[92:95], v[100:103], v[240:243]
    ds_read_b64_tr_b16 v[140:141], v41 offset:40960
    v_mfma_f32_16x16x32_bf16 v[196:199], v[64:67], v[104:107], v[196:199]
    ds_read_b64_tr_b16 v[142:143], v41 offset:41984
    v_mfma_f32_16x16x32_bf16 v[196:199], v[68:71], v[108:111], v[196:199]
    ds_read_b64_tr_b16 v[144:145], v42 offset:32768
    v_mfma_f32_16x16x32_bf16 v[212:215], v[72:75], v[104:107], v[212:215]
    ds_read_b64_tr_b16 v[146:147], v42 offset:33792
    v_mfma_f32_16x16x32_bf16 v[212:215], v[76:79], v[108:111], v[212:215]
    ds_read_b64_tr_b16 v[148:149], v42 offset:40960
    v_mfma_f32_16x16x32_bf16 v[228:231], v[80:83], v[104:107], v[228:231]
    ds_read_b64_tr_b16 v[150:151], v42 offset:41984
    v_mfma_f32_16x16x32_bf16 v[228:231], v[84:87], v[108:111], v[228:231]
    ds_read_b64_tr_b16 v[152:153], v43 offset:32768
    v_mfma_f32_16x16x32_bf16 v[244:247], v[88:91], v[104:107], v[244:247]
    ds_read_b64_tr_b16 v[154:155], v43 offset:33792
    v_mfma_f32_16x16x32_bf16 v[244:247], v[92:95], v[108:111], v[244:247]
    ds_read_b64_tr_b16 v[156:157], v43 offset:40960
    v_mfma_f32_16x16x32_bf16 v[200:203], v[64:67], v[112:115], v[200:203]
    ds_read_b64_tr_b16 v[158:159], v43 offset:41984
    v_mfma_f32_16x16x32_bf16 v[200:203], v[68:71], v[116:119], v[200:203]
    ds_read_b128 v[160:163], v44 offset:32768
    v_mfma_f32_16x16x32_bf16 v[216:219], v[72:75], v[112:115], v[216:219]
    ds_read_b128 v[164:167], v44 offset:33792
    v_mfma_f32_16x16x32_bf16 v[216:219], v[76:79], v[116:119], v[216:219]
    ds_read_b128 v[168:171], v44 offset:34816
    v_mfma_f32_16x16x32_bf16 v[232:235], v[80:83], v[112:115], v[232:235]
    ds_read_b128 v[172:175], v44 offset:35840
    v_mfma_f32_16x16x32_bf16 v[232:235], v[84:87], v[116:119], v[232:235]
    ds_read_b128 v[176:179], v44 offset:36864
    v_mfma_f32_16x16x32_bf16 v[248:251], v[88:91], v[112:115], v[248:251]
    ds_read_b128 v[180:183], v44 offset:37888
    v_mfma_f32_16x16x32_bf16 v[248:251], v[92:95], v[116:119], v[248:251]
    ds_read_b128 v[184:187], v44 offset:38912
    s_waitcnt lgkmcnt(5)
    v_mfma_f32_16x16x32_bf16 v[192:195], v[128:131], v[160:163], v[192:195]
    ds_read_b128 v[188:191], v44 offset:39936
    v_mfma_f32_16x16x32_bf16 v[192:195], v[132:135], v[164:167], v[192:195]
    v_mfma_f32_16x16x32_bf16 v[208:211], v[136:139], v[160:163], v[208:211]
    v_mfma_f32_16x16x32_bf16 v[208:211], v[140:143], v[164:167], v[208:211]
    v_mfma_f32_16x16x32_bf16 v[224:227], v[144:147], v[160:163], v[224:227]
    v_mfma_f32_16x16x32_bf16 v[224:227], v[148:151], v[164:167], v[224:227]
    v_mfma_f32_16x16x32_bf16 v[240:243], v[152:155], v[160:163], v[240:243]
    v_mfma_f32_16x16x32_bf16 v[240:243], v[156:159], v[164:167], v[240:243]
    s_waitcnt lgkmcnt(4)
    v_mfma_f32_16x16x32_bf16 v[196:199], v[128:131], v[168:171], v[196:199]
    v_mfma_f32_16x16x32_bf16 v[196:199], v[132:135], v[172:175], v[196:199]
    ds_write_b128 v32, v[192:195] offset:0
    v_mfma_f32_16x16x32_bf16 v[212:215], v[136:139], v[168:171], v[212:215]
    ds_write_b128 v32, v[208:211] offset:64
    v_mfma_f32_16x16x32_bf16 v[212:215], v[140:143], v[172:175], v[212:215]
    ds_write_b128 v32, v[224:227] offset:128
    v_mfma_f32_16x16x32_bf16 v[228:231], v[144:147], v[168:171], v[228:231]
    ds_write_b128 v32, v[240:243] offset:192
    ds_read_b128 v[192:195], v33 offset:0
    v_mfma_f32_16x16x32_bf16 v[228:231], v[148:151], v[172:175], v[228:231]
    ds_read_b128 v[208:211], v33 offset:1088
    ds_read_b128 v[224:227], v33 offset:2176
    v_mfma_f32_16x16x32_bf16 v[244:247], v[152:155], v[168:171], v[244:247]
    ds_read_b128 v[240:243], v33 offset:3264
    v_mfma_f32_16x16x32_bf16 v[244:247], v[156:159], v[172:175], v[244:247]
    s_waitcnt lgkmcnt(3)
    buffer_store_dwordx4 v[192:195], v46, s[56:59], s64 offen sc1
    s_add_u32 s64, s64, 0x8000
    s_waitcnt lgkmcnt(10)
    v_mfma_f32_16x16x32_bf16 v[200:203], v[128:131], v[176:179], v[200:203]
    s_waitcnt lgkmcnt(2)
    buffer_store_dwordx4 v[208:211], v46, s[56:59], s64 offen sc1
    s_add_u32 s64, s64, 0x8000
    v_mfma_f32_16x16x32_bf16 v[200:203], v[132:135], v[180:183], v[200:203]
    ds_write_b128 v32, v[196:199] offset:0
    s_waitcnt lgkmcnt(2)
    buffer_store_dwordx4 v[224:227], v46, s[56:59], s64 offen sc1
    s_add_u32 s64, s64, 0x8000
    v_mfma_f32_16x16x32_bf16 v[216:219], v[136:139], v[176:179], v[216:219]
    ds_write_b128 v32, v[212:215] offset:64
    s_waitcnt lgkmcnt(2)
    buffer_store_dwordx4 v[240:243], v46, s[56:59], s64 offen sc1
    s_add_u32 s64, s64, 0x8000
    v_mfma_f32_16x16x32_bf16 v[216:219], v[140:143], v[180:183], v[216:219]
    ds_write_b128 v32, v[228:231] offset:128
    v_mfma_f32_16x16x32_bf16 v[232:235], v[144:147], v[176:179], v[232:235]
    ds_write_b128 v32, v[244:247] offset:192
    ds_read_b128 v[196:199], v33 offset:0
    v_mfma_f32_16x16x32_bf16 v[232:235], v[148:151], v[180:183], v[232:235]
    ds_read_b128 v[212:215], v33 offset:1088
    ds_read_b128 v[228:231], v33 offset:2176
    v_mfma_f32_16x16x32_bf16 v[248:251], v[152:155], v[176:179], v[248:251]
    ds_read_b128 v[244:247], v33 offset:3264
    v_mfma_f32_16x16x32_bf16 v[248:251], v[156:159], v[180:183], v[248:251]
    s_waitcnt lgkmcnt(3)
    buffer_store_dwordx4 v[196:199], v46, s[56:59], s65 offen sc1
    s_add_u32 s65, s65, 0x8000
    v_mfma_f32_16x16x32_bf16 v[204:207], v[64:67], v[120:123], v[204:207]
    s_waitcnt lgkmcnt(2)
    buffer_store_dwordx4 v[212:215], v46, s[56:59], s65 offen sc1
    s_add_u32 s65, s65, 0x8000
    v_mfma_f32_16x16x32_bf16 v[204:207], v[68:71], v[124:127], v[204:207]
    ds_write_b128 v32, v[200:203] offset:0
    s_waitcnt lgkmcnt(2)
    buffer_store_dwordx4 v[228:231], v46, s[56:59], s65 offen sc1
    s_add_u32 s65, s65, 0x8000
    v_mfma_f32_16x16x32_bf16 v[220:223], v[72:75], v[120:123], v[220:223]
    ds_write_b128 v32, v[216:219] offset:64
    s_waitcnt lgkmcnt(2)
    buffer_store_dwordx4 v[244:247], v46, s[56:59], s65 offen sc1
    s_add_u32 s65, s65, 0x8000
    v_mfma_f32_16x16x32_bf16 v[220:223], v[76:79], v[124:127], v[220:223]
    ds_write_b128 v32, v[232:235] offset:128
    v_mfma_f32_16x16x32_bf16 v[236:239], v[80:83], v[120:123], v[236:239]
    ds_write_b128 v32, v[248:251] offset:192
    ds_read_b128 v[200:203], v33 offset:0
    v_mfma_f32_16x16x32_bf16 v[236:239], v[84:87], v[124:127], v[236:239]
    ds_read_b128 v[216:219], v33 offset:1088
    ds_read_b128 v[232:235], v33 offset:2176
    v_mfma_f32_16x16x32_bf16 v[252:255], v[88:91], v[120:123], v[252:255]
    ds_read_b128 v[248:251], v33 offset:3264
    v_mfma_f32_16x16x32_bf16 v[252:255], v[92:95], v[124:127], v[252:255]
    s_waitcnt lgkmcnt(3)
    buffer_store_dwordx4 v[200:203], v46, s[56:59], s66 offen sc1
    s_add_u32 s66, s66, 0x8000
    s_waitcnt lgkmcnt(15)
    v_mfma_f32_16x16x32_bf16 v[204:207], v[128:131], v[184:187], v[204:207]
    s_waitcnt lgkmcnt(2)
    buffer_store_dwordx4 v[216:219], v46, s[56:59], s66 offen sc1
    s_add_u32 s66, s66, 0x8000
    v_mfma_f32_16x16x32_bf16 v[204:207], v[132:135], v[188:191], v[204:207]
    s_waitcnt lgkmcnt(1)
    buffer_store_dwordx4 v[232:235], v46, s[56:59], s66 offen sc1
    s_add_u32 s66, s66, 0x8000
    v_mfma_f32_16x16x32_bf16 v[220:223], v[136:139], v[184:187], v[220:223]
    s_waitcnt lgkmcnt(0)
    buffer_store_dwordx4 v[248:251], v46, s[56:59], s66 offen sc1
    s_add_u32 s66, s66, 0x8000
    v_mfma_f32_16x16x32_bf16 v[220:223], v[140:143], v[188:191], v[220:223]
    v_mfma_f32_16x16x32_bf16 v[236:239], v[144:147], v[184:187], v[236:239]
    v_mfma_f32_16x16x32_bf16 v[236:239], v[148:151], v[188:191], v[236:239]
    v_mfma_f32_16x16x32_bf16 v[252:255], v[152:155], v[184:187], v[252:255]
    v_mfma_f32_16x16x32_bf16 v[252:255], v[156:159], v[188:191], v[252:255]
    s_nop 4
    ds_write_b128 v32, v[204:207] offset:0
    ds_write_b128 v32, v[220:223] offset:64
    ds_write_b128 v32, v[236:239] offset:128
    ds_write_b128 v32, v[252:255] offset:192
    ds_read_b128 v[204:207], v33 offset:0
    ds_read_b128 v[220:223], v33 offset:1088
    ds_read_b128 v[236:239], v33 offset:2176
    ds_read_b128 v[252:255], v33 offset:3264
    s_waitcnt lgkmcnt(3)
    buffer_store_dwordx4 v[204:207], v46, s[56:59], s67 offen sc1
    s_add_u32 s67, s67, 0x8000
    s_waitcnt lgkmcnt(2)
    buffer_store_dwordx4 v[220:223], v46, s[56:59], s67 offen sc1
    s_add_u32 s67, s67, 0x8000
    s_waitcnt lgkmcnt(1)
    buffer_store_dwordx4 v[236:239], v46, s[56:59], s67 offen sc1
    s_add_u32 s67, s67, 0x8000
    s_waitcnt lgkmcnt(0)
    buffer_store_dwordx4 v[252:255], v46, s[56:59], s67 offen sc1
    s_add_u32 s67, s67, 0x8000
    s_branch L_g1end_3
L_spin_46:
    s_mov_b32 s76, 400000
L_sp_55:
    s_sleep 1
    buffer_load_dword v45, v44, s[40:43], s64 offen sc1
    s_waitcnt vmcnt(0)
    v_cmp_ne_u32 vcc, 1, v45
    s_bfm_b64 s[100:101], s68, 0
    s_and_b64 vcc, vcc, s[100:101]
    s_cbranch_scc0 L_spinr_47
    s_sub_u32 s76, s76, 1
    s_cmp_lg_u32 s76, 0
    s_cbranch_scc1 L_sp_55
    s_branch L_spinr_47
L_spin_51:
    s_mov_b32 s76, 400000
L_sp_56:
    s_sleep 1
    buffer_load_dword v49, v48, s[40:43], s77 offen sc1
    s_waitcnt vmcnt(0)
    v_cmp_ne_u32 vcc, 1, v49
    s_mov_b64 s[100:101], -1
    s_and_b64 vcc, vcc, s[100:101]
    s_cbranch_scc0 L_spinr_52
    s_sub_u32 s76, s76, 1
    s_cmp_lg_u32 s76, 0
    s_cbranch_scc1 L_sp_56
    s_branch L_spinr_52
L_g1end_3:
    s_branch L_fin
L_group2:
    s_lshl_b32 s73, s81, 12
    s_add_u32 s74, s73, 16384
    v_lshlrev_b32 v37, 4, v0
    v_add_u32 v38, 98304, v37
    v_add_u32 v37, 131072, v37
    v_mov_b32 v39, 0xdddddddd
    v_and_b32 v49, 7, v0
    v_mov_b32 v51, 0x3f803f80
    v_cmp_eq_u32 vcc, 0, v49
    v_cmp_eq_u32 s[100:101], 4, v49
    s_nop 0
    v_cndmask_b32 v48, 0, v51, vcc
    v_cndmask_b32 v50, 0, v51, s[100:101]
    v_mov_b32 v51, v50
    v_mov_b32 v49, v48
    v_mov_b32 v40, 0
    v_mov_b32 v41, 0
    v_mov_b32 v42, 0
    v_mov_b32 v43, 0
    v_mov_b32 v44, 0
    v_mov_b32 v45, 0
    v_mov_b32 v46, 0
    v_mov_b32 v47, 0
    s_lshl3_add_u32 s80, s39, s3
    s_lshl2_add_u32 s80, s80, s81
    s_lshl_b32 s77, s80, 12
    v_and_b32 v1, 31, v0
    v_lshl_add_u32 v1, v1, 7, s77
    s_waitcnt lgkmcnt(0)
    s_mov_b32 s44, s24
    s_mov_b32 s45, s25
    s_mov_b32 s46, 0x200000
    s_mov_b32 s47, 0x20000
    buffer_load_dword v7, v1, s[44:47], 0 offen
    s_mov_b32 s79, 0x200000
    s_lshl3_add_u32 s77, s39, s3
    s_lshl2_add_u32 s77, s77, s81
    s_cmp_lt_u32 s77, 0x180
    s_cselect_b64 s[52:53], s[10:11], s[12:13]
    s_cmp_lt_u32 s77, 0x100
    s_cselect_b64 s[52:53], s[4:5], s[52:53]
    s_cselect_b32 s54, 0x400000, s79
    s_mov_b32 s55, 0x20000
    s_movk_i32 s78, 0x7f
    s_cmov_b32 s78, 0xff
    s_and_b32 s77, s77, s78
    s_lshl_b32 s77, s77, 14
    v_bfe_u32 v1, v0, 2, 3
    v_and_b32 v2, 3, v0
    v_lshl_add_u32 v1, v1, 4, v2
    v_lshl_add_u32 v30, v1, 7, s77
    buffer_load_dword v7, v30, s[52:55], 0 offen offset:0
    s_mov_b32 s40, s36
    s_mov_b32 s41, s37
    s_mov_b32 s42, 0x10000000
    s_mov_b32 s43, 0x20000
    s_mov_b32 s56, s32
    s_mov_b32 s57, s33
    s_mov_b32 s58, 0x1000000
    s_mov_b32 s59, 0x20000
    s_mov_b32 s60, s34
    s_mov_b32 s61, s35
    s_mov_b32 s62, 0x100
    s_mov_b32 s63, 0x20000
    s_cmp_lg_u32 s80, 0
    s_cbranch_scc1 L_noinit_59
    v_lshlrev_b32 v1, 4, v0
    s_mov_b32 s77, 0
    buffer_store_dwordx4 v[40:43], v1, s[40:43], s77 offen sc1
    s_mov_b32 s77, 1024
    buffer_store_dwordx4 v[40:43], v1, s[40:43], s77 offen sc1
    s_mov_b32 s77, 2048
    buffer_store_dwordx4 v[40:43], v1, s[40:43], s77 offen sc1
    s_mov_b32 s77, 3072
    buffer_store_dwordx4 v[40:43], v1, s[40:43], s77 offen sc1
    s_mov_b32 s77, 4096
    buffer_store_dwordx4 v[40:43], v1, s[40:43], s77 offen sc1
    s_mov_b32 s77, 5120
    buffer_store_dwordx4 v[40:43], v1, s[40:43], s77 offen sc1
    s_mov_b32 s77, 6144
    buffer_store_dwordx4 v[40:43], v1, s[40:43], s77 offen sc1
    s_mov_b32 s77, 7168
    buffer_store_dwordx4 v[40:43], v1, s[40:43], s77 offen sc1
    s_mov_b32 s77, 8192
    buffer_store_dwordx4 v[40:43], v1, s[40:43], s77 offen sc1
    s_mov_b32 s77, 9216
    buffer_store_dwordx4 v[40:43], v1, s[40:43], s77 offen sc1
    s_mov_b32 s77, 10240
    buffer_store_dwordx4 v[40:43], v1, s[40:43], s77 offen sc1
    s_mov_b32 s77, 11264
    buffer_store_dwordx4 v[40:43], v1, s[40:43], s77 offen sc1
    s_mov_b32 s77, 12288
    buffer_store_dwordx4 v[40:43], v1, s[40:43], s77 offen sc1
    s_mov_b32 s77, 13312
    buffer_store_dwordx4 v[40:43], v1, s[40:43], s77 offen sc1
    v_mov_b32 v1, 1
    s_waitcnt vmcnt(0)
    s_mov_b64 exec, 1
    buffer_store_dword v1, off, s[60:63], 0 sc1
    s_mov_b64 exec, -1
L_noinit_59:
    s_and_b32 s78, s38, 1
    s_lshl_b32 s78, s78, 1
    v_bfe_u32 v1, v0, 2, 2
    v_lshrrev_b32 v2, 4, v0
    v_lshl_add_u32 v2, v2, 3, v1
    v_bfe_u32 v1, v0, 2, 3
    v_xor_b32 v1, s78, v1
    v_lshlrev_b32 v1, 5, v1
    v_lshl_add_u32 v2, v2, 8, v1
    v_and_b32 v3, 3, v0
    v_lshl_add_u32 v22, v3, 3, v2
    v_xor_b32 v23, 32, v22
    v_xor_b32 v24, 128, v22
    v_xor_b32 v25, 160, v22
    s_lshr_b32 s78, s38, 1
    s_lshl_b32 s78, s78, 13
    s_add_u32 s78, s78, 16384
    v_and_b32 v1, 15, v0
    v_lshrrev_b32 v2, 4, v0
    v_bfe_u32 v3, v0, 1, 3
    v_xor_b32 v2, v2, v3
    v_lshlrev_b32 v2, 4, v2
    v_lshl_add_u32 v2, v1, 7, v2
    v_add_u32 v26, s78, v2
    v_xor_b32 v27, 64, v26
    v_mfma_f32_32x32x16_bf16 v[192:207], v[40:43], v[40:43], 0
    v_mfma_f32_32x32x16_bf16 v[208:223], v[40:43], v[40:43], 0
    v_mfma_f32_32x32x16_bf16 v[224:239], v[40:43], v[40:43], 0
    v_mfma_f32_32x32x16_bf16 v[240:255], v[40:43], v[40:43], 0
    s_lshl_b32 s77, s81, 12
    v_lshl_add_u32 v52, v0, 4, s77
    s_lshl2_add_u32 s78, s3, s81
    s_lshl_b32 s78, s78, 5
    v_lshrrev_b32 v1, 3, v0
    v_and_b32 v2, 7, v0
    v_lshrrev_b32 v3, 1, v1
    v_xor_b32 v2, v2, v3
    v_add_lshl_u32 v1, v1, s78, 11
    v_lshl_add_u32 v53, v2, 4, v1
    v_xor_b32 v1, 64, v53
    v_add_u32 v54, 15360, v1
    v_add_u32 v55, 30720, v53
    v_add_u32 v56, 46080, v1
    s_lshl3_add_u32 s65, s39, s3
    s_and_b32 s78, s38, 2
    s_lshl3_add_u32 s65, s65, s78
    s_and_b32 s78, s38, 1
    s_lshl2_add_u32 s65, s65, s78
    s_lshl_b32 s65, s65, 10
    s_add_u32 s65, s65, 4194304
    v_and_b32 v1, 15, v0
    v_lshrrev_b32 v2, 5, v0
    v_lshl_add_u32 v1, v2, 4, v1
    v_bfe_u32 v2, v0, 4, 1
    v_lshlrev_b32 v1, 4, v1
    v_lshl_add_u32 v57, v2, 11, v1
    s_lshl3_add_u32 s66, s39, s3
    s_lshl2_add_u32 s66, s66, s38
    s_lshl_b32 s66, s66, 12
    s_add_u32 s66, s66, 2097152
    v_lshlrev_b32 v10, 4, v0
    s_mov_b32 s48, s14
    s_mov_b32 s49, s15
    s_mov_b32 s50, 0x200000
    s_mov_b32 s51, 0x20000
    s_lshl_b32 s82, s39, 19
    s_add_u32 s82, s82, 8388608
    s_lshl_b32 s72, s3, 8
    s_add_u32 s72, s72, 384
    s_and_b32 s72, s72, 2047
    s_mov_b32 s75, 98304
    s_lshr_b32 s64, s39, 1
    s_lshl_b32 s64, s64, 8
    s_add_u32 s64, s64, 12288
    v_lshlrev_b32 v8, 2, v0
    s_barrier
    ds_read_b64_tr_b16 v[64:65], v22 offset:0
    ds_read_b64_tr_b16 v[66:67], v22 offset:1024
    ds_read_b64_tr_b16 v[68:69], v22 offset:8192
    ds_read_b64_tr_b16 v[70:71], v22 offset:9216
    ds_read_b128 v[96:99], v26 offset:0
    ds_read_b128 v[100:103], v27 offset:0
    ds_read_b128 v[104:107], v26 offset:2048
    ds_read_b128 v[108:111], v27 offset:2048
    ds_read_b128 v[112:115], v26 offset:4096
    ds_read_b128 v[116:119], v27 offset:4096
    ds_read_b128 v[120:123], v26 offset:6144
    ds_read_b128 v[124:127], v27 offset:6144
    ds_read_b64_tr_b16 v[72:73], v23 offset:0
    ds_read_b64_tr_b16 v[74:75], v23 offset:1024
    ds_read_b64_tr_b16 v[76:77], v23 offset:8192
    ds_read_b64_tr_b16 v[78:79], v23 offset:9216
    ds_read_b64_tr_b16 v[80:81], v24 offset:0
    ds_read_b64_tr_b16 v[82:83], v24 offset:1024
    ds_read_b64_tr_b16 v[84:85], v24 offset:8192
    ds_read_b64_tr_b16 v[86:87], v24 offset:9216
    ds_read_b64_tr_b16 v[88:89], v25 offset:0
    ds_read_b64_tr_b16 v[90:91], v25 offset:1024
    ds_read_b64_tr_b16 v[92:93], v25 offset:8192
    ds_read_b64_tr_b16 v[94:95], v25 offset:9216
    s_mov_b32 s70, 0
    .p2align 3
L_gloop_60:
    s_waitcnt lgkmcnt(0)
    v_mfma_f32_16x16x32_bf16 v[192:195], v[64:67], v[96:99], v[192:195]
    s_barrier
    v_mfma_f32_16x16x32_bf16 v[192:195], v[68:71], v[100:103], v[192:195]
    ds_read_b64_tr_b16 v[128:129], v22 offset:32768
    v_mfma_f32_16x16x32_bf16 v[196:199], v[64:67], v[104:107], v[196:199]
    ds_read_b64_tr_b16 v[130:131], v22 offset:33792
    v_mfma_f32_16x16x32_bf16 v[196:199], v[68:71], v[108:111], v[196:199]
    ds_read_b64_tr_b16 v[132:133], v22 offset:40960
    v_mfma_f32_16x16x32_bf16 v[200:203], v[64:67], v[112:115], v[200:203]
    ds_read_b64_tr_b16 v[134:135], v22 offset:41984
    v_mfma_f32_16x16x32_bf16 v[200:203], v[68:71], v[116:119], v[200:203]
    ds_read_b128 v[160:163], v26 offset:32768
    v_mfma_f32_16x16x32_bf16 v[204:207], v[64:67], v[120:123], v[204:207]
    ds_read_b128 v[164:167], v27 offset:32768
    v_mfma_f32_16x16x32_bf16 v[204:207], v[68:71], v[124:127], v[204:207]
    ds_read_b128 v[168:171], v26 offset:34816
    v_mfma_f32_16x16x32_bf16 v[220:223], v[72:75], v[120:123], v[220:223]
    ds_read_b128 v[172:175], v27 offset:34816
    v_mfma_f32_16x16x32_bf16 v[220:223], v[76:79], v[124:127], v[220:223]
    ds_read_b128 v[176:179], v26 offset:36864
    v_mfma_f32_16x16x32_bf16 v[216:219], v[72:75], v[112:115], v[216:219]
    ds_read_b128 v[180:183], v27 offset:36864
    v_mfma_f32_16x16x32_bf16 v[216:219], v[76:79], v[116:119], v[216:219]
    ds_read_b128 v[184:187], v26 offset:38912
    v_mfma_f32_16x16x32_bf16 v[212:215], v[72:75], v[104:107], v[212:215]
    ds_read_b128 v[188:191], v27 offset:38912
    v_mfma_f32_16x16x32_bf16 v[212:215], v[76:79], v[108:111], v[212:215]
    ds_read_b64_tr_b16 v[136:137], v23 offset:32768
    v_mfma_f32_16x16x32_bf16 v[208:211], v[72:75], v[96:99], v[208:211]
    ds_read_b64_tr_b16 v[138:139], v23 offset:33792
    v_mfma_f32_16x16x32_bf16 v[208:211], v[76:79], v[100:103], v[208:211]
    ds_read_b64_tr_b16 v[140:141], v23 offset:40960
    v_mfma_f32_16x16x32_bf16 v[224:227], v[80:83], v[96:99], v[224:227]
    ds_read_b64_tr_b16 v[142:143], v23 offset:41984
    v_mfma_f32_16x16x32_bf16 v[224:227], v[84:87], v[100:103], v[224:227]
    ds_read_b64_tr_b16 v[144:145], v24 offset:32768
    v_mfma_f32_16x16x32_bf16 v[228:231], v[80:83], v[104:107], v[228:231]
    ds_read_b64_tr_b16 v[146:147], v24 offset:33792
    v_mfma_f32_16x16x32_bf16 v[228:231], v[84:87], v[108:111], v[228:231]
    ds_read_b64_tr_b16 v[148:149], v24 offset:40960
    v_mfma_f32_16x16x32_bf16 v[232:235], v[80:83], v[112:115], v[232:235]
    ds_read_b64_tr_b16 v[150:151], v24 offset:41984
    v_mfma_f32_16x16x32_bf16 v[232:235], v[84:87], v[116:119], v[232:235]
    ds_read_b64_tr_b16 v[152:153], v25 offset:32768
    v_mfma_f32_16x16x32_bf16 v[236:239], v[80:83], v[120:123], v[236:239]
    ds_read_b64_tr_b16 v[154:155], v25 offset:33792
    v_mfma_f32_16x16x32_bf16 v[236:239], v[84:87], v[124:127], v[236:239]
    ds_read_b64_tr_b16 v[156:157], v25 offset:40960
    v_mfma_f32_16x16x32_bf16 v[252:255], v[88:91], v[120:123], v[252:255]
    ds_read_b64_tr_b16 v[158:159], v25 offset:41984
    v_mfma_f32_16x16x32_bf16 v[252:255], v[92:95], v[124:127], v[252:255]
    v_xor_b32 v22, 0x10000, v22
    v_mfma_f32_16x16x32_bf16 v[248:251], v[88:91], v[112:115], v[248:251]
    v_xor_b32 v23, 0x10000, v23
    v_mfma_f32_16x16x32_bf16 v[248:251], v[92:95], v[116:119], v[248:251]
    v_xor_b32 v24, 0x10000, v24
    v_mfma_f32_16x16x32_bf16 v[244:247], v[88:91], v[104:107], v[244:247]
    v_xor_b32 v25, 0x10000, v25
    v_mfma_f32_16x16x32_bf16 v[244:247], v[92:95], v[108:111], v[244:247]
    v_xor_b32 v26, 0x10000, v26
    v_mfma_f32_16x16x32_bf16 v[240:243], v[88:91], v[96:99], v[240:243]
    v_xor_b32 v27, 0x10000, v27
    v_mfma_f32_16x16x32_bf16 v[240:243], v[92:95], v[100:103], v[240:243]
    s_bitcmp1_b32 34, s70
    s_waitcnt lgkmcnt(0)
    v_mfma_f32_16x16x32_bf16 v[192:195], v[128:131], v[160:163], v[192:195]
    s_cbranch_scc1 L_hk_61
L_hkr_62:
    s_barrier
    v_mfma_f32_16x16x32_bf16 v[192:195], v[132:135], v[164:167], v[192:195]
    ds_read_b64_tr_b16 v[64:65], v22 offset:0
    v_mfma_f32_16x16x32_bf16 v[196:199], v[128:131], v[168:171], v[196:199]
    ds_read_b64_tr_b16 v[66:67], v22 offset:1024
    v_mfma_f32_16x16x32_bf16 v[196:199], v[132:135], v[172:175], v[196:199]
    ds_read_b64_tr_b16 v[68:69], v22 offset:8192
    v_mfma_f32_16x16x32_bf16 v[200:203], v[128:131], v[176:179], v[200:203]
    ds_read_b64_tr_b16 v[70:71], v22 offset:9216
    v_mfma_f32_16x16x32_bf16 v[200:203], v[132:135], v[180:183], v[200:203]
    ds_read_b128 v[96:99], v26 offset:0
    v_mfma_f32_16x16x32_bf16 v[204:207], v[128:131], v[184:187], v[204:207]
    ds_read_b128 v[100:103], v27 offset:0
    v_mfma_f32_16x16x32_bf16 v[204:207], v[132:135], v[188:191], v[204:207]
    ds_read_b128 v[104:107], v26 offset:2048
    v_mfma_f32_16x16x32_bf16 v[220:223], v[136:139], v[184:187], v[220:223]
    ds_read_b128 v[108:111], v27 offset:2048
    v_mfma_f32_16x16x32_bf16 v[220:223], v[140:143], v[188:191], v[220:223]
    ds_read_b128 v[112:115], v26 offset:4096
    v_mfma_f32_16x16x32_bf16 v[216:219], v[136:139], v[176:179], v[216:219]
    ds_read_b128 v[116:119], v27 offset:4096
    v_mfma_f32_16x16x32_bf16 v[216:219], v[140:143], v[180:183], v[216:219]
    ds_read_b128 v[120:123], v26 offset:6144
    v_mfma_f32_16x16x32_bf16 v[212:215], v[136:139], v[168:171], v[212:215]
    ds_read_b128 v[124:127], v27 offset:6144
    v_mfma_f32_16x16x32_bf16 v[212:215], v[140:143], v[172:175], v[212:215]
    ds_read_b64_tr_b16 v[72:73], v23 offset:0
    v_mfma_f32_16x16x32_bf16 v[208:211], v[136:139], v[160:163], v[208:211]
    ds_read_b64_tr_b16 v[74:75], v23 offset:1024
    v_mfma_f32_16x16x32_bf16 v[208:211], v[140:143], v[164:167], v[208:211]
    ds_read_b64_tr_b16 v[76:77], v23 offset:8192
    v_mfma_f32_16x16x32_bf16 v[224:227], v[144:147], v[160:163], v[224:227]
    ds_read_b64_tr_b16 v[78:79], v23 offset:9216
    v_mfma_f32_16x16x32_bf16 v[224:227], v[148:151], v[164:167], v[224:227]
    ds_read_b64_tr_b16 v[80:81], v24 offset:0
    v_mfma_f32_16x16x32_bf16 v[228:231], v[144:147], v[168:171], v[228:231]
    ds_read_b64_tr_b16 v[82:83], v24 offset:1024
    v_mfma_f32_16x16x32_bf16 v[228:231], v[148:151], v[172:175], v[228:231]
    ds_read_b64_tr_b16 v[84:85], v24 offset:8192
    v_mfma_f32_16x16x32_bf16 v[232:235], v[144:147], v[176:179], v[232:235]
    ds_read_b64_tr_b16 v[86:87], v24 offset:9216
    v_mfma_f32_16x16x32_bf16 v[232:235], v[148:151], v[180:183], v[232:235]
    ds_read_b64_tr_b16 v[88:89], v25 offset:0
    v_mfma_f32_16x16x32_bf16 v[236:239], v[144:147], v[184:187], v[236:239]
    ds_read_b64_tr_b16 v[90:91], v25 offset:1024
    v_mfma_f32_16x16x32_bf16 v[236:239], v[148:151], v[188:191], v[236:239]
    ds_read_b64_tr_b16 v[92:93], v25 offset:8192
    v_mfma_f32_16x16x32_bf16 v[252:255], v[152:155], v[184:187], v[252:255]
    ds_read_b64_tr_b16 v[94:95], v25 offset:9216
    v_mfma_f32_16x16x32_bf16 v[252:255], v[156:159], v[188:191], v[252:255]
    s_add_u32 s70, s70, 1
    v_mfma_f32_16x16x32_bf16 v[248:251], v[152:155], v[176:179], v[248:251]
    s_cmp_lg_u32 s70, 8
    v_mfma_f32_16x16x32_bf16 v[248:251], v[156:159], v[180:183], v[248:251]
    v_mfma_f32_16x16x32_bf16 v[244:247], v[152:155], v[168:171], v[244:247]
    v_mfma_f32_16x16x32_bf16 v[244:247], v[156:159], v[172:175], v[244:247]
    v_mfma_f32_16x16x32_bf16 v[240:243], v[152:155], v[160:163], v[240:243]
    v_mfma_f32_16x16x32_bf16 v[240:243], v[156:159], v[164:167], v[240:243]
    s_cbranch_scc1 L_gloop_60
    s_waitcnt lgkmcnt(0)
    ds_read_b128 v[80:83], v37 offset:0
    ds_read_b128 v[84:87], v37 offset:1024
    ds_read_b128 v[88:91], v37 offset:4096
    ds_read_b128 v[92:95], v37 offset:5120
    ds_read_b128 v[96:99], v37 offset:2048
    v_mov_b32 v100, 0
    v_mov_b32 v101, 0
    v_mov_b32 v102, 0
    v_mov_b32 v103, 0
    v_mfma_f32_32x32x16_bf16 v[120:135], v[40:43], v[40:43], 0
    v_mfma_f32_32x32x16_bf16 v[152:167], v[40:43], v[40:43], 0
    v_mfma_f32_32x32x16_bf16 v[136:151], v[40:43], v[40:43], 0
    s_mov_b32 s70, 0
    s_mov_b32 s84, 98304
    v_cvt_pk_bf16_f32 v64, v192, v193
    v_cvt_pk_bf16_f32 v65, v194, v195
    v_cvt_pk_bf16_f32 v66, v196, v197
    v_cvt_pk_bf16_f32 v67, v198, v199
    v_cvt_pk_bf16_f32 v68, v208, v209
    v_cvt_pk_bf16_f32 v69, v210, v211
    v_cvt_pk_bf16_f32 v70, v212, v213
    v_cvt_pk_bf16_f32 v71, v214, v215
    v_permlane16_swap_b32 v64, v66
    v_permlane16_swap_b32 v65, v67
    v_permlane16_swap_b32 v68, v70
    v_permlane16_swap_b32 v69, v71
    s_nop 0
    s_waitcnt lgkmcnt(3)
    v_mfma_f32_32x32x16_bf16 v[104:119], v[80:83], v[64:67], 0
    v_mfma_f32_32x32x16_bf16 v[104:119], v[84:87], v[68:71], v[104:119]
    v_cvt_pk_bf16_f32 v168, v224, v225
    v_cvt_pk_bf16_f32 v169, v226, v227
    v_cvt_pk_bf16_f32 v170, v228, v229
    v_cvt_pk_bf16_f32 v171, v230, v231
    v_cvt_pk_bf16_f32 v172, v240, v241
    v_cvt_pk_bf16_f32 v173, v242, v243
    v_cvt_pk_bf16_f32 v174, v244, v245
    v_cvt_pk_bf16_f32 v175, v246, v247
    v_permlane16_swap_b32 v168, v170
    v_permlane16_swap_b32 v169, v171
    v_permlane16_swap_b32 v172, v174
    v_permlane16_swap_b32 v173, v175
    buffer_store_dwordx4 v[168:171], v10, s[40:43], s66 offen offset:0 sc1
    buffer_store_dwordx4 v[172:175], v10, s[40:43], s66 offen offset:1024 sc1
    v_cvt_pk_bf16_f32 v72, v200, v201
    v_cvt_pk_bf16_f32 v73, v202, v203
    v_cvt_pk_bf16_f32 v74, v204, v205
    v_cvt_pk_bf16_f32 v75, v206, v207
    v_cvt_pk_bf16_f32 v76, v216, v217
    v_cvt_pk_bf16_f32 v77, v218, v219
    v_cvt_pk_bf16_f32 v78, v220, v221
    v_cvt_pk_bf16_f32 v79, v222, v223
    v_permlane16_swap_b32 v72, v74
    v_permlane16_swap_b32 v73, v75
    v_permlane16_swap_b32 v76, v78
    v_permlane16_swap_b32 v77, v79
    v_cvt_pk_bf16_f32 v176, v232, v233
    v_cvt_pk_bf16_f32 v177, v234, v235
    v_cvt_pk_bf16_f32 v178, v236, v237
    v_cvt_pk_bf16_f32 v179, v238, v239
    v_cvt_pk_bf16_f32 v180, v248, v249
    v_cvt_pk_bf16_f32 v181, v250, v251
    v_cvt_pk_bf16_f32 v182, v252, v253
    v_cvt_pk_bf16_f32 v183, v254, v255
    v_permlane16_swap_b32 v176, v178
    v_permlane16_swap_b32 v177, v179
    v_permlane16_swap_b32 v180, v182
    v_permlane16_swap_b32 v181, v183
    buffer_store_dwordx4 v[176:179], v10, s[40:43], s66 offen offset:2048 sc1
    buffer_store_dwordx4 v[180:183], v10, s[40:43], s66 offen offset:3072 sc1
    s_setprio 0
    s_barrier
    .p2align 3
L_att_63:
    v_exp_f32 v104, v104
    v_exp_f32 v105, v105
    v_smfmac_f32_32x32x32_bf16 v[152:167], v[100:103], v[128:135], v39
    v_exp_f32 v106, v106
    v_exp_f32 v107, v107
    v_exp_f32 v108, v108
    v_smfmac_f32_16x16x64_bf16 v[44:47], v[48:51], v[128:135], v39
    ds_read_b128 v[100:103], v37 offset:3072
    v_exp_f32 v109, v109
    v_mfma_f32_32x32x16_bf16 v[120:135], v[80:83], v[72:75], 0
    v_exp_f32 v110, v110
    v_exp_f32 v111, v111
    v_exp_f32 v112, v112
    v_mfma_f32_32x32x16_bf16 v[120:135], v[84:87], v[76:79], v[120:135]
    s_waitcnt lgkmcnt(1)
    v_exp_f32 v113, v113
    v_exp_f32 v114, v114
    v_exp_f32 v115, v115
    v_exp_f32 v116, v116
    v_smfmac_f32_32x32x32_bf16 v[136:151], v[96:99], v[104:111], v39
    s_waitcnt lgkmcnt(0)
    v_exp_f32 v117, v117
    v_exp_f32 v118, v118
    v_exp_f32 v119, v119
    v_smfmac_f32_16x16x64_bf16 v[40:43], v[48:51], v[104:111], v39
    ds_read_b128 v[80:83], v37 offset:8192
    v_exp_f32 v120, v120
    v_exp_f32 v121, v121
    v_smfmac_f32_32x32x32_bf16 v[136:151], v[100:103], v[112:119], v39
    v_exp_f32 v122, v122
    v_exp_f32 v123, v123
    v_exp_f32 v124, v124
    v_smfmac_f32_16x16x64_bf16 v[40:43], v[48:51], v[112:119], v39
    ds_read_b128 v[84:87], v37 offset:9216
    v_exp_f32 v125, v125
    v_mfma_f32_32x32x16_bf16 v[104:119], v[88:91], v[64:67], 0
    v_exp_f32 v126, v126
    v_exp_f32 v127, v127
    v_exp_f32 v128, v128
    v_mfma_f32_32x32x16_bf16 v[104:119], v[92:95], v[68:71], v[104:119]
    s_nop 0
    v_exp_f32 v129, v129
    v_exp_f32 v130, v130
    v_exp_f32 v131, v131
    v_exp_f32 v132, v132
    v_smfmac_f32_32x32x32_bf16 v[152:167], v[96:99], v[120:127], v39
    s_nop 0
    v_exp_f32 v133, v133
    v_exp_f32 v134, v134
    v_exp_f32 v135, v135
    v_smfmac_f32_16x16x64_bf16 v[44:47], v[48:51], v[120:127], v39
    ds_read_b128 v[96:99], v37 offset:6144
    v_exp_f32 v104, v104
    v_exp_f32 v105, v105
    v_smfmac_f32_32x32x32_bf16 v[152:167], v[100:103], v[128:135], v39
    v_exp_f32 v106, v106
    v_exp_f32 v107, v107
    v_exp_f32 v108, v108
    v_smfmac_f32_16x16x64_bf16 v[44:47], v[48:51], v[128:135], v39
    ds_read_b128 v[100:103], v37 offset:7168
    v_exp_f32 v109, v109
    v_mfma_f32_32x32x16_bf16 v[120:135], v[88:91], v[72:75], 0
    v_exp_f32 v110, v110
    v_exp_f32 v111, v111
    v_exp_f32 v112, v112
    v_mfma_f32_32x32x16_bf16 v[120:135], v[92:95], v[76:79], v[120:135]
    s_waitcnt lgkmcnt(1)
    v_exp_f32 v113, v113
    v_exp_f32 v114, v114
    v_exp_f32 v115, v115
    v_exp_f32 v116, v116
    v_smfmac_f32_32x32x32_bf16 v[136:151], v[96:99], v[104:111], v39
    s_waitcnt lgkmcnt(0)
    v_exp_f32 v117, v117
    v_exp_f32 v118, v118
    v_exp_f32 v119, v119
    v_smfmac_f32_16x16x64_bf16 v[40:43], v[48:51], v[104:111], v39
    ds_read_b128 v[88:91], v37 offset:12288
    v_exp_f32 v120, v120
    v_exp_f32 v121, v121
    v_smfmac_f32_32x32x32_bf16 v[136:151], v[100:103], v[112:119], v39
    v_exp_f32 v122, v122
    v_exp_f32 v123, v123
    v_exp_f32 v124, v124
    v_smfmac_f32_16x16x64_bf16 v[40:43], v[48:51], v[112:119], v39
    ds_read_b128 v[92:95], v37 offset:13312
    v_exp_f32 v125, v125
    v_mfma_f32_32x32x16_bf16 v[104:119], v[80:83], v[64:67], 0
    v_exp_f32 v126, v126
    v_exp_f32 v127, v127
    v_exp_f32 v128, v128
    v_mfma_f32_32x32x16_bf16 v[104:119], v[84:87], v[68:71], v[104:119]
    s_nop 0
    v_exp_f32 v129, v129
    v_exp_f32 v130, v130
    v_exp_f32 v131, v131
    v_exp_f32 v132, v132
    v_smfmac_f32_32x32x32_bf16 v[152:167], v[96:99], v[120:127], v39
    s_nop 0
    v_exp_f32 v133, v133
    v_exp_f32 v134, v134
    v_exp_f32 v135, v135
    v_smfmac_f32_16x16x64_bf16 v[44:47], v[48:51], v[120:127], v39
    ds_read_b128 v[96:99], v37 offset:10240
    v_exp_f32 v104, v104
    v_exp_f32 v105, v105
    v_smfmac_f32_32x32x32_bf16 v[152:167], v[100:103], v[128:135], v39
    v_exp_f32 v106, v106
    v_exp_f32 v107, v107
    v_exp_f32 v108, v108
    v_smfmac_f32_16x16x64_bf16 v[44:47], v[48:51], v[128:135], v39
    ds_read_b128 v[100:103], v37 offset:11264
    v_exp_f32 v109, v109
    v_mfma_f32_32x32x16_bf16 v[120:135], v[80:83], v[72:75], 0
    v_exp_f32 v110, v110
    v_exp_f32 v111, v111
    v_exp_f32 v112, v112
    v_mfma_f32_32x32x16_bf16 v[120:135], v[84:87], v[76:79], v[120:135]
    s_waitcnt lgkmcnt(1)
    v_exp_f32 v113, v113
    v_exp_f32 v114, v114
    v_exp_f32 v115, v115
    v_exp_f32 v116, v116
    v_smfmac_f32_32x32x32_bf16 v[136:151], v[96:99], v[104:111], v39
    s_waitcnt lgkmcnt(0)
    v_exp_f32 v117, v117
    v_exp_f32 v118, v118
    v_exp_f32 v119, v119
    v_smfmac_f32_16x16x64_bf16 v[40:43], v[48:51], v[104:111], v39
    ds_read_b128 v[80:83], v37 offset:16384
    v_exp_f32 v120, v120
    v_exp_f32 v121, v121
    v_smfmac_f32_32x32x32_bf16 v[136:151], v[100:103], v[112:119], v39
    v_exp_f32 v122, v122
    v_exp_f32 v123, v123
    v_exp_f32 v124, v124
    v_smfmac_f32_16x16x64_bf16 v[40:43], v[48:51], v[112:119], v39
    ds_read_b128 v[84:87], v37 offset:17408
    v_exp_f32 v125, v125
    v_mfma_f32_32x32x16_bf16 v[104:119], v[88:91], v[64:67], 0
    v_exp_f32 v126, v126
    v_exp_f32 v127, v127
    v_exp_f32 v128, v128
    v_mfma_f32_32x32x16_bf16 v[104:119], v[92:95], v[68:71], v[104:119]
    s_nop 0
    v_exp_f32 v129, v129
    v_exp_f32 v130, v130
    v_exp_f32 v131, v131
    v_exp_f32 v132, v132
    v_smfmac_f32_32x32x32_bf16 v[152:167], v[96:99], v[120:127], v39
    s_nop 0
    v_exp_f32 v133, v133
    v_exp_f32 v134, v134
    v_exp_f32 v135, v135
    v_smfmac_f32_16x16x64_bf16 v[44:47], v[48:51], v[120:127], v39
    ds_read_b128 v[96:99], v37 offset:14336
    v_exp_f32 v104, v104
    v_exp_f32 v105, v105
    v_smfmac_f32_32x32x32_bf16 v[152:167], v[100:103], v[128:135], v39
    v_exp_f32 v106, v106
    v_exp_f32 v107, v107
    v_exp_f32 v108, v108
    v_smfmac_f32_16x16x64_bf16 v[44:47], v[48:51], v[128:135], v39
    ds_read_b128 v[100:103], v37 offset:15360
    v_exp_f32 v109, v109
    v_mfma_f32_32x32x16_bf16 v[120:135], v[88:91], v[72:75], 0
    v_exp_f32 v110, v110
    v_exp_f32 v111, v111
    v_exp_f32 v112, v112
    v_mfma_f32_32x32x16_bf16 v[120:135], v[92:95], v[76:79], v[120:135]
    s_waitcnt lgkmcnt(1)
    v_exp_f32 v113, v113
    v_exp_f32 v114, v114
    v_exp_f32 v115, v115
    v_exp_f32 v116, v116
    v_smfmac_f32_32x32x32_bf16 v[136:151], v[96:99], v[104:111], v39
    s_waitcnt lgkmcnt(0)
    v_exp_f32 v117, v117
    v_exp_f32 v118, v118
    v_exp_f32 v119, v119
    v_smfmac_f32_16x16x64_bf16 v[40:43], v[48:51], v[104:111], v39
    ds_read_b128 v[88:91], v37 offset:20480
    v_exp_f32 v120, v120
    v_exp_f32 v121, v121
    v_smfmac_f32_32x32x32_bf16 v[136:151], v[100:103], v[112:119], v39
    s_sub_u32 s84, s84, 0x8000
    v_exp_f32 v122, v122
    v_exp_f32 v123, v123
    v_exp_f32 v124, v124
    v_smfmac_f32_16x16x64_bf16 v[40:43], v[48:51], v[112:119], v39
    ds_read_b128 v[92:95], v37 offset:21504
    v_exp_f32 v125, v125
    v_mfma_f32_32x32x16_bf16 v[104:119], v[80:83], v[64:67], 0
    s_cmp_lt_u32 s84, 65536
    v_exp_f32 v126, v126
    v_exp_f32 v127, v127
    v_exp_f32 v128, v128
    v_mfma_f32_32x32x16_bf16 v[104:119], v[84:87], v[68:71], v[104:119]
    s_cselect_b32 s84, 131072, s84
    v_exp_f32 v129, v129
    v_exp_f32 v130, v130
    v_exp_f32 v131, v131
    v_exp_f32 v132, v132
    v_smfmac_f32_32x32x32_bf16 v[152:167], v[96:99], v[120:127], v39
    s_nop 0
    v_exp_f32 v133, v133
    v_exp_f32 v134, v134
    v_exp_f32 v135, v135
    v_smfmac_f32_16x16x64_bf16 v[44:47], v[48:51], v[120:127], v39
    ds_read_b128 v[96:99], v37 offset:18432
    v_exp_f32 v104, v104
    v_exp_f32 v105, v105
    v_smfmac_f32_32x32x32_bf16 v[152:167], v[100:103], v[128:135], v39
    v_exp_f32 v106, v106
    v_exp_f32 v107, v107
    v_exp_f32 v108, v108
    v_smfmac_f32_16x16x64_bf16 v[44:47], v[48:51], v[128:135], v39
    ds_read_b128 v[100:103], v37 offset:19456
    v_exp_f32 v109, v109
    v_mfma_f32_32x32x16_bf16 v[120:135], v[80:83], v[72:75], 0
    v_exp_f32 v110, v110
    v_exp_f32 v111, v111
    v_exp_f32 v112, v112
    v_mfma_f32_32x32x16_bf16 v[120:135], v[84:87], v[76:79], v[120:135]
    s_waitcnt lgkmcnt(1)
    v_exp_f32 v113, v113
    v_exp_f32 v114, v114
    v_exp_f32 v115, v115
    v_exp_f32 v116, v116
    v_smfmac_f32_32x32x32_bf16 v[136:151], v[96:99], v[104:111], v39
    s_waitcnt lgkmcnt(0)
    v_exp_f32 v117, v117
    v_exp_f32 v118, v118
    v_exp_f32 v119, v119
    v_smfmac_f32_16x16x64_bf16 v[40:43], v[48:51], v[104:111], v39
    ds_read_b128 v[80:83], v37 offset:24576
    v_exp_f32 v120, v120
    v_exp_f32 v121, v121
    v_smfmac_f32_32x32x32_bf16 v[136:151], v[100:103], v[112:119], v39
    v_exp_f32 v122, v122
    v_exp_f32 v123, v123
    v_exp_f32 v124, v124
    v_smfmac_f32_16x16x64_bf16 v[40:43], v[48:51], v[112:119], v39
    ds_read_b128 v[84:87], v37 offset:25600
    v_exp_f32 v125, v125
    v_mfma_f32_32x32x16_bf16 v[104:119], v[88:91], v[64:67], 0
    v_exp_f32 v126, v126
    v_exp_f32 v127, v127
    v_exp_f32 v128, v128
    v_mfma_f32_32x32x16_bf16 v[104:119], v[92:95], v[68:71], v[104:119]
    s_nop 0
    v_exp_f32 v129, v129
    v_exp_f32 v130, v130
    v_exp_f32 v131, v131
    v_exp_f32 v132, v132
    v_smfmac_f32_32x32x32_bf16 v[152:167], v[96:99], v[120:127], v39
    s_nop 0
    v_exp_f32 v133, v133
    v_exp_f32 v134, v134
    v_exp_f32 v135, v135
    v_smfmac_f32_16x16x64_bf16 v[44:47], v[48:51], v[120:127], v39
    ds_read_b128 v[96:99], v37 offset:22528
    v_exp_f32 v104, v104
    v_exp_f32 v105, v105
    v_smfmac_f32_32x32x32_bf16 v[152:167], v[100:103], v[128:135], v39
    v_exp_f32 v106, v106
    v_exp_f32 v107, v107
    v_exp_f32 v108, v108
    v_smfmac_f32_16x16x64_bf16 v[44:47], v[48:51], v[128:135], v39
    ds_read_b128 v[100:103], v37 offset:23552
    v_exp_f32 v109, v109
    v_mfma_f32_32x32x16_bf16 v[120:135], v[88:91], v[72:75], 0
    v_exp_f32 v110, v110
    v_exp_f32 v111, v111
    v_exp_f32 v112, v112
    v_mfma_f32_32x32x16_bf16 v[120:135], v[92:95], v[76:79], v[120:135]
    s_waitcnt lgkmcnt(1)
    v_exp_f32 v113, v113
    v_exp_f32 v114, v114
    v_exp_f32 v115, v115
    v_exp_f32 v116, v116
    v_smfmac_f32_32x32x32_bf16 v[136:151], v[96:99], v[104:111], v39
    s_waitcnt lgkmcnt(0)
    v_exp_f32 v117, v117
    v_exp_f32 v118, v118
    v_exp_f32 v119, v119
    v_smfmac_f32_16x16x64_bf16 v[40:43], v[48:51], v[104:111], v39
    ds_read_b128 v[88:91], v37 offset:28672
    v_exp_f32 v120, v120
    v_exp_f32 v121, v121
    v_smfmac_f32_32x32x32_bf16 v[136:151], v[100:103], v[112:119], v39
    v_exp_f32 v122, v122
    v_exp_f32 v123, v123
    v_exp_f32 v124, v124
    v_smfmac_f32_16x16x64_bf16 v[40:43], v[48:51], v[112:119], v39
    ds_read_b128 v[92:95], v37 offset:29696
    v_exp_f32 v125, v125
    v_mfma_f32_32x32x16_bf16 v[104:119], v[80:83], v[64:67], 0
    v_exp_f32 v126, v126
    v_exp_f32 v127, v127
    v_exp_f32 v128, v128
    v_mfma_f32_32x32x16_bf16 v[104:119], v[84:87], v[68:71], v[104:119]
    s_nop 0
    v_exp_f32 v129, v129
    v_exp_f32 v130, v130
    v_exp_f32 v131, v131
    v_exp_f32 v132, v132
    v_smfmac_f32_32x32x32_bf16 v[152:167], v[96:99], v[120:127], v39
    s_nop 0
    v_exp_f32 v133, v133
    v_exp_f32 v134, v134
    v_exp_f32 v135, v135
    v_smfmac_f32_16x16x64_bf16 v[44:47], v[48:51], v[120:127], v39
    ds_read_b128 v[96:99], v37 offset:26624
    v_exp_f32 v104, v104
    v_exp_f32 v105, v105
    v_smfmac_f32_32x32x32_bf16 v[152:167], v[100:103], v[128:135], v39
    v_exp_f32 v106, v106
    v_exp_f32 v107, v107
    v_exp_f32 v108, v108
    v_smfmac_f32_16x16x64_bf16 v[44:47], v[48:51], v[128:135], v39
    ds_read_b128 v[100:103], v37 offset:27648
    v_exp_f32 v109, v109
    v_mfma_f32_32x32x16_bf16 v[120:135], v[80:83], v[72:75], 0
    v_exp_f32 v110, v110
    v_exp_f32 v111, v111
    v_exp_f32 v112, v112
    v_mfma_f32_32x32x16_bf16 v[120:135], v[84:87], v[76:79], v[120:135]
    s_waitcnt lgkmcnt(1)
    v_exp_f32 v113, v113
    v_exp_f32 v114, v114
    v_exp_f32 v115, v115
    v_exp_f32 v116, v116
    v_smfmac_f32_32x32x32_bf16 v[136:151], v[96:99], v[104:111], v39
    s_waitcnt vmcnt(0) lgkmcnt(0)
    s_barrier
    v_exp_f32 v117, v117
    v_exp_f32 v118, v118
    v_exp_f32 v119, v119
    v_smfmac_f32_16x16x64_bf16 v[40:43], v[48:51], v[104:111], v39
    ds_read_b128 v[80:83], v38 offset:0
    v_exp_f32 v120, v120
    v_exp_f32 v121, v121
    v_smfmac_f32_32x32x32_bf16 v[136:151], v[100:103], v[112:119], v39
    v_exp_f32 v122, v122
    v_exp_f32 v123, v123
    v_exp_f32 v124, v124
    v_smfmac_f32_16x16x64_bf16 v[40:43], v[48:51], v[112:119], v39
    ds_read_b128 v[84:87], v38 offset:1024
    v_exp_f32 v125, v125
    v_mfma_f32_32x32x16_bf16 v[104:119], v[88:91], v[64:67], 0
    v_exp_f32 v126, v126
    v_exp_f32 v127, v127
    v_exp_f32 v128, v128
    v_mfma_f32_32x32x16_bf16 v[104:119], v[92:95], v[68:71], v[104:119]
    s_nop 0
    v_exp_f32 v129, v129
    v_exp_f32 v130, v130
    v_exp_f32 v131, v131
    v_exp_f32 v132, v132
    v_smfmac_f32_32x32x32_bf16 v[152:167], v[96:99], v[120:127], v39
    s_nop 0
    v_exp_f32 v133, v133
    v_exp_f32 v134, v134
    v_exp_f32 v135, v135
    v_smfmac_f32_16x16x64_bf16 v[44:47], v[48:51], v[120:127], v39
    ds_read_b128 v[96:99], v37 offset:30720
    v_exp_f32 v104, v104
    v_exp_f32 v105, v105
    v_smfmac_f32_32x32x32_bf16 v[152:167], v[100:103], v[128:135], v39
    v_exp_f32 v106, v106
    v_exp_f32 v107, v107
    v_exp_f32 v108, v108
    v_smfmac_f32_16x16x64_bf16 v[44:47], v[48:51], v[128:135], v39
    ds_read_b128 v[100:103], v37 offset:31744
    v_exp_f32 v109, v109
    v_mfma_f32_32x32x16_bf16 v[120:135], v[88:91], v[72:75], 0
    v_mov_b32 v37, v38
    v_lshl_add_u32 v38, v0, 4, s84
    v_exp_f32 v110, v110
    v_exp_f32 v111, v111
    v_exp_f32 v112, v112
    v_mfma_f32_32x32x16_bf16 v[120:135], v[92:95], v[76:79], v[120:135]
    s_waitcnt lgkmcnt(1)
    v_exp_f32 v113, v113
    v_exp_f32 v114, v114
    v_exp_f32 v115, v115
    v_exp_f32 v116, v116
    v_smfmac_f32_32x32x32_bf16 v[136:151], v[96:99], v[104:111], v39
    s_waitcnt lgkmcnt(0)
    v_exp_f32 v117, v117
    v_exp_f32 v118, v118
    v_exp_f32 v119, v119
    v_smfmac_f32_16x16x64_bf16 v[40:43], v[48:51], v[104:111], v39
    ds_read_b128 v[88:91], v37 offset:4096
    v_exp_f32 v120, v120
    v_exp_f32 v121, v121
    v_smfmac_f32_32x32x32_bf16 v[136:151], v[100:103], v[112:119], v39
    v_exp_f32 v122, v122
    v_exp_f32 v123, v123
    v_exp_f32 v124, v124
    v_smfmac_f32_16x16x64_bf16 v[40:43], v[48:51], v[112:119], v39
    ds_read_b128 v[92:95], v37 offset:5120
    v_exp_f32 v125, v125
    v_mfma_f32_32x32x16_bf16 v[104:119], v[80:83], v[64:67], 0
    s_add_u32 s70, s70, 1
    v_exp_f32 v126, v126
    v_exp_f32 v127, v127
    v_exp_f32 v128, v128
    v_mfma_f32_32x32x16_bf16 v[104:119], v[84:87], v[68:71], v[104:119]
    s_cmp_lt_u32 s70, 8
    v_exp_f32 v129, v129
    v_exp_f32 v130, v130
    v_exp_f32 v131, v131
    v_exp_f32 v132, v132
    v_smfmac_f32_32x32x32_bf16 v[152:167], v[96:99], v[120:127], v39
    s_nop 0
    v_exp_f32 v133, v133
    v_exp_f32 v134, v134
    v_exp_f32 v135, v135
    v_smfmac_f32_16x16x64_bf16 v[44:47], v[48:51], v[120:127], v39
    ds_read_b128 v[96:99], v37 offset:2048
    s_cbranch_scc1 L_att_63
    v_smfmac_f32_32x32x32_bf16 v[152:167], v[100:103], v[128:135], v39
    v_smfmac_f32_16x16x64_bf16 v[44:47], v[48:51], v[128:135], v39
    s_waitcnt lgkmcnt(0)
    s_mov_b32 s79, 0x2b800000
    s_barrier
    s_lshl_b32 s71, s72, 7
    s_add_u32 s71, s71, s82
    s_add_u32 m0, s75, s73
    s_nop 0
    buffer_load_dwordx4 v53, s[48:51], s72 offen offset:0 lds
    v_fma_f32 v4, 0, v136, v40
    v_fmac_f32 v4, 0, v137
    v_fmac_f32 v4, 0, v138
    v_fmac_f32 v4, 0, v139
    v_fmac_f32 v4, 0, v140
    v_fmac_f32 v4, 0, v141
    buffer_load_dwordx4 v54, s[48:51], s72 offen offset:1024 lds
    v_fmac_f32 v4, 0, v142
    v_fmac_f32 v4, 0, v143
    v_fmac_f32 v4, 0, v144
    v_fmac_f32 v4, 0, v145
    v_fmac_f32 v4, 0, v146
    buffer_load_dwordx4 v55, s[48:51], s72 offen offset:2048 lds
    v_fmac_f32 v4, 0, v147
    v_fmac_f32 v4, 0, v148
    v_fmac_f32 v4, 0, v149
    v_fmac_f32 v4, 0, v150
    v_fmac_f32 v4, 0, v151
    v_cmp_ngt_f32 vcc, 0x76800000, v4
    v_cmp_nle_f32 s[100:101], s79, v4
    buffer_load_dwordx4 v56, s[48:51], s72 offen offset:3072 lds
    s_nop 0
    s_or_b64 vcc, vcc, s[100:101]
    s_cbranch_scc1 L_slow_64
L_slowr_65:
    v_rcp_f32 v4, v40
    s_add_u32 m0, s75, s74
    s_nop 0
    buffer_load_dwordx4 v52, s[40:43], s71 offen offset:0 sc1 lds
    v_mul_f32 v136, v136, v4
    v_mul_f32 v137, v137, v4
    v_mul_f32 v138, v138, v4
    v_mul_f32 v139, v139, v4
    v_mul_f32 v140, v140, v4
    v_mul_f32 v141, v141, v4
    buffer_load_dwordx4 v52, s[40:43], s71 offen offset:1024 sc1 lds
    v_mul_f32 v142, v142, v4
    v_mul_f32 v143, v143, v4
    v_mul_f32 v144, v144, v4
    v_mul_f32 v145, v145, v4
    v_mul_f32 v146, v146, v4
    v_mul_f32 v147, v147, v4
    buffer_load_dwordx4 v52, s[40:43], s71 offen offset:2048 sc1 lds
    v_mul_f32 v148, v148, v4
    v_mul_f32 v149, v149, v4
    v_mul_f32 v150, v150, v4
    v_mul_f32 v151, v151, v4
    v_cvt_pk_bf16_f32 v168, v136, v137
    v_cvt_pk_bf16_f32 v169, v138, v139
    v_cvt_pk_bf16_f32 v170, v140, v141
    v_cvt_pk_bf16_f32 v171, v142, v143
    v_cvt_pk_bf16_f32 v172, v144, v145
    v_cvt_pk_bf16_f32 v173, v146, v147
    v_cvt_pk_bf16_f32 v174, v148, v149
    v_cvt_pk_bf16_f32 v175, v150, v151
    buffer_store_dwordx4 v[168:171], v57, s[40:43], s65 offen offset:0 sc1
    buffer_store_dwordx4 v[172:175], v57, s[40:43], s65 offen offset:512 sc1
    s_add_u32 s65, s65, 0x1000
    buffer_load_dwordx4 v52, s[40:43], s71 offen offset:3072 sc1 lds
    s_add_u32 s72, s72, 128
    s_and_b32 s72, s72, 2047
    s_add_u32 s75, s75, 0x8000
    s_and_b32 s75, s75, 0x1ffff
    s_barrier
    s_lshl_b32 s71, s72, 7
    s_add_u32 s71, s71, s82
    s_add_u32 m0, s75, s73
    s_nop 0
    buffer_load_dwordx4 v53, s[48:51], s72 offen offset:0 lds
    v_fma_f32 v4, 0, v152, v44
    v_fmac_f32 v4, 0, v153
    v_fmac_f32 v4, 0, v154
    v_fmac_f32 v4, 0, v155
    v_fmac_f32 v4, 0, v156
    v_fmac_f32 v4, 0, v157
    buffer_load_dwordx4 v54, s[48:51], s72 offen offset:1024 lds
    v_fmac_f32 v4, 0, v158
    v_fmac_f32 v4, 0, v159
    v_fmac_f32 v4, 0, v160
    v_fmac_f32 v4, 0, v161
    v_fmac_f32 v4, 0, v162
    buffer_load_dwordx4 v55, s[48:51], s72 offen offset:2048 lds
    v_fmac_f32 v4, 0, v163
    v_fmac_f32 v4, 0, v164
    v_fmac_f32 v4, 0, v165
    v_fmac_f32 v4, 0, v166
    v_fmac_f32 v4, 0, v167
    v_cmp_ngt_f32 vcc, 0x76800000, v4
    v_cmp_nle_f32 s[100:101], s79, v4
    buffer_load_dwordx4 v56, s[48:51], s72 offen offset:3072 lds
    s_nop 0
    s_or_b64 vcc, vcc, s[100:101]
    s_cbranch_scc1 L_slow_66
L_slowr_67:
    v_rcp_f32 v4, v44
    s_add_u32 m0, s75, s74
    s_nop 0
    buffer_load_dwordx4 v52, s[40:43], s71 offen offset:0 sc1 lds
    v_mul_f32 v152, v152, v4
    v_mul_f32 v153, v153, v4
    v_mul_f32 v154, v154, v4
    v_mul_f32 v155, v155, v4
    v_mul_f32 v156, v156, v4
    v_mul_f32 v157, v157, v4
    buffer_load_dwordx4 v52, s[40:43], s71 offen offset:1024 sc1 lds
    v_mul_f32 v158, v158, v4
    v_mul_f32 v159, v159, v4
    v_mul_f32 v160, v160, v4
    v_mul_f32 v161, v161, v4
    v_mul_f32 v162, v162, v4
    v_mul_f32 v163, v163, v4
    buffer_load_dwordx4 v52, s[40:43], s71 offen offset:2048 sc1 lds
    v_mul_f32 v164, v164, v4
    v_mul_f32 v165, v165, v4
    v_mul_f32 v166, v166, v4
    v_mul_f32 v167, v167, v4
    v_cvt_pk_bf16_f32 v176, v152, v153
    v_cvt_pk_bf16_f32 v177, v154, v155
    v_cvt_pk_bf16_f32 v178, v156, v157
    v_cvt_pk_bf16_f32 v179, v158, v159
    v_cvt_pk_bf16_f32 v180, v160, v161
    v_cvt_pk_bf16_f32 v181, v162, v163
    v_cvt_pk_bf16_f32 v182, v164, v165
    v_cvt_pk_bf16_f32 v183, v166, v167
    buffer_store_dwordx4 v[176:179], v57, s[40:43], s65 offen offset:0 sc1
    buffer_store_dwordx4 v[180:183], v57, s[40:43], s65 offen offset:512 sc1
    s_add_u32 s65, s65, 0x1000
    buffer_load_dwordx4 v52, s[40:43], s71 offen offset:3072 sc1 lds
    s_add_u32 s72, s72, 128
    s_and_b32 s72, s72, 2047
    s_add_u32 s75, s75, 0x8000
    s_and_b32 s75, s75, 0x1ffff
    s_mov_b32 s70, 3
L_lloop_68:
    s_lshl_b32 s71, s72, 7
    s_add_u32 s71, s71, s82
    s_add_u32 m0, s75, s73
    s_nop 0
    buffer_load_dwordx4 v53, s[48:51], s72 offen offset:0 lds
    buffer_load_dwordx4 v54, s[48:51], s72 offen offset:1024 lds
    s_waitcnt vmcnt(10)
    s_barrier
L_lloop_68_r:
    buffer_load_dwordx4 v55, s[48:51], s72 offen offset:2048 lds
    buffer_load_dwordx4 v56, s[48:51], s72 offen offset:3072 lds
    s_add_u32 m0, s75, s74
    s_nop 0
    buffer_load_dwordx4 v52, s[40:43], s71 offen offset:0 sc1 lds
    buffer_load_dwordx4 v52, s[40:43], s71 offen offset:1024 sc1 lds
    buffer_load_dwordx4 v52, s[40:43], s71 offen offset:2048 sc1 lds
    buffer_load_dwordx4 v52, s[40:43], s71 offen offset:3072 sc1 lds
    s_add_u32 s72, s72, 128
    s_and_b32 s72, s72, 2047
    s_add_u32 s75, s75, 0x8000
    s_and_b32 s75, s75, 0x1ffff
L_lloop0_69:
    s_bitcmp1_b32 9224, s70
    s_cbranch_scc1 L_hk_70
L_hkr_71:
    s_add_u32 s70, s70, 1
    s_cmp_lg_u32 s70, 30
    s_cbranch_scc1 L_lloop_68
    s_waitcnt vmcnt(8)
    s_barrier
    s_waitcnt vmcnt(0)
    s_barrier
    s_branch L_qend_58
L_hk_61:
    s_cmp_eq_u32 s70, 5
    s_cbranch_scc1 L_hn_73
L_hn_72:
    buffer_load_dword v7, v30, s[52:55], 0 offen offset:512
    s_branch L_hkr_62
L_hn_73:
    buffer_load_dword v7, v30, s[52:55], 0 offen offset:1024
    s_branch L_hkr_62
L_slow_64:
    v_lshlrev_b32 v1, 4, v0
    v_mov_b32 v2, 0xff800000
    s_mov_b32 s77, 65536
L_slow1_74:
    buffer_load_dwordx4 v[80:83], v1, s[40:43], s77 offen sc1
    buffer_load_dwordx4 v[84:87], v1, s[40:43], s77 offen offset:1024 sc1
    s_waitcnt vmcnt(0)
    v_mfma_f32_32x32x16_bf16 v[104:119], v[80:83], v[64:67], 0
    v_mfma_f32_32x32x16_bf16 v[104:119], v[84:87], v[68:71], v[104:119]
    s_nop 15
    v_max3_f32 v2, v2, v104, v105
    v_max3_f32 v2, v2, v106, v107
    v_max3_f32 v2, v2, v108, v109
    v_max3_f32 v2, v2, v110, v111
    v_max3_f32 v2, v2, v112, v113
    v_max3_f32 v2, v2, v114, v115
    v_max3_f32 v2, v2, v116, v117
    v_max3_f32 v2, v2, v118, v119
    s_add_u32 s77, s77, 4096
    s_cmp_lt_u32 s77, 327680
    s_cbranch_scc1 L_slow1_74
    v_mov_b32 v120, v2
    s_nop 1
    v_permlane32_swap_b32 v120, v2
    s_nop 1
    v_max_f32 v2, v2, v120
    v_sub_f32 v120, 0, v2
    v_sub_f32 v121, 0, v2
    v_sub_f32 v122, 0, v2
    v_sub_f32 v123, 0, v2
    v_sub_f32 v124, 0, v2
    v_sub_f32 v125, 0, v2
    v_sub_f32 v126, 0, v2
    v_sub_f32 v127, 0, v2
    v_sub_f32 v128, 0, v2
    v_sub_f32 v129, 0, v2
    v_sub_f32 v130, 0, v2
    v_sub_f32 v131, 0, v2
    v_sub_f32 v132, 0, v2
    v_sub_f32 v133, 0, v2
    v_sub_f32 v134, 0, v2
    v_sub_f32 v135, 0, v2
    v_mov_b32 v136, 0
    v_mov_b32 v137, 0
    v_mov_b32 v138, 0
    v_mov_b32 v139, 0
    v_mov_b32 v140, 0
    v_mov_b32 v141, 0
    v_mov_b32 v142, 0
    v_mov_b32 v143, 0
    v_mov_b32 v144, 0
    v_mov_b32 v145, 0
    v_mov_b32 v146, 0
    v_mov_b32 v147, 0
    v_mov_b32 v148, 0
    v_mov_b32 v149, 0
    v_mov_b32 v150, 0
    v_mov_b32 v151, 0
    v_mov_b32 v40, 0
    v_mov_b32 v41, 0
    v_mov_b32 v42, 0
    v_mov_b32 v43, 0
    s_mov_b32 s77, 65536
L_slow2_75:
    buffer_load_dwordx4 v[80:83], v1, s[40:43], s77 offen offset:0 sc1
    buffer_load_dwordx4 v[84:87], v1, s[40:43], s77 offen offset:1024 sc1
    buffer_load_dwordx4 v[96:99], v1, s[40:43], s77 offen offset:2048 sc1
    buffer_load_dwordx4 v[100:103], v1, s[40:43], s77 offen offset:3072 sc1
    s_waitcnt vmcnt(0)
    v_mfma_f32_32x32x16_bf16 v[104:119], v[80:83], v[64:67], v[120:135]
    v_mfma_f32_32x32x16_bf16 v[104:119], v[84:87], v[68:71], v[104:119]
    s_nop 15
    v_exp_f32 v104, v104
    v_exp_f32 v105, v105
    v_exp_f32 v106, v106
    v_exp_f32 v107, v107
    v_exp_f32 v108, v108
    v_exp_f32 v109, v109
    v_exp_f32 v110, v110
    v_exp_f32 v111, v111
    v_exp_f32 v112, v112
    v_exp_f32 v113, v113
    v_exp_f32 v114, v114
    v_exp_f32 v115, v115
    v_exp_f32 v116, v116
    v_exp_f32 v117, v117
    v_exp_f32 v118, v118
    v_exp_f32 v119, v119
    s_nop 2
    v_smfmac_f32_32x32x32_bf16 v[136:151], v[96:99], v[104:111], v39
    v_smfmac_f32_32x32x32_bf16 v[136:151], v[100:103], v[112:119], v39
    v_smfmac_f32_16x16x64_bf16 v[40:43], v[48:51], v[104:111], v39
    v_smfmac_f32_16x16x64_bf16 v[40:43], v[48:51], v[112:119], v39
    s_add_u32 s77, s77, 4096
    s_cmp_lt_u32 s77, 327680
    s_cbranch_scc1 L_slow2_75
    s_nop 15
    s_branch L_slowr_65
L_slow_66:
    v_lshlrev_b32 v1, 4, v0
    v_mov_b32 v2, 0xff800000
    s_mov_b32 s77, 65536
L_slow1_76:
    buffer_load_dwordx4 v[80:83], v1, s[40:43], s77 offen sc1
    buffer_load_dwordx4 v[84:87], v1, s[40:43], s77 offen offset:1024 sc1
    s_waitcnt vmcnt(0)
    v_mfma_f32_32x32x16_bf16 v[104:119], v[80:83], v[72:75], 0
    v_mfma_f32_32x32x16_bf16 v[104:119], v[84:87], v[76:79], v[104:119]
    s_nop 15
    v_max3_f32 v2, v2, v104, v105
    v_max3_f32 v2, v2, v106, v107
    v_max3_f32 v2, v2, v108, v109
    v_max3_f32 v2, v2, v110, v111
    v_max3_f32 v2, v2, v112, v113
    v_max3_f32 v2, v2, v114, v115
    v_max3_f32 v2, v2, v116, v117
    v_max3_f32 v2, v2, v118, v119
    s_add_u32 s77, s77, 4096
    s_cmp_lt_u32 s77, 327680
    s_cbranch_scc1 L_slow1_76
    v_mov_b32 v120, v2
    s_nop 1
    v_permlane32_swap_b32 v120, v2
    s_nop 1
    v_max_f32 v2, v2, v120
    v_sub_f32 v120, 0, v2
    v_sub_f32 v121, 0, v2
    v_sub_f32 v122, 0, v2
    v_sub_f32 v123, 0, v2
    v_sub_f32 v124, 0, v2
    v_sub_f32 v125, 0, v2
    v_sub_f32 v126, 0, v2
    v_sub_f32 v127, 0, v2
    v_sub_f32 v128, 0, v2
    v_sub_f32 v129, 0, v2
    v_sub_f32 v130, 0, v2
    v_sub_f32 v131, 0, v2
    v_sub_f32 v132, 0, v2
    v_sub_f32 v133, 0, v2
    v_sub_f32 v134, 0, v2
    v_sub_f32 v135, 0, v2
    v_mov_b32 v152, 0
    v_mov_b32 v153, 0
    v_mov_b32 v154, 0
    v_mov_b32 v155, 0
    v_mov_b32 v156, 0
    v_mov_b32 v157, 0
    v_mov_b32 v158, 0
    v_mov_b32 v159, 0
    v_mov_b32 v160, 0
    v_mov_b32 v161, 0
    v_mov_b32 v162, 0
    v_mov_b32 v163, 0
    v_mov_b32 v164, 0
    v_mov_b32 v165, 0
    v_mov_b32 v166, 0
    v_mov_b32 v167, 0
    v_mov_b32 v44, 0
    v_mov_b32 v45, 0
    v_mov_b32 v46, 0
    v_mov_b32 v47, 0
    s_mov_b32 s77, 65536
L_slow2_77:
    buffer_load_dwordx4 v[80:83], v1, s[40:43], s77 offen offset:0 sc1
    buffer_load_dwordx4 v[84:87], v1, s[40:43], s77 offen offset:1024 sc1
    buffer_load_dwordx4 v[96:99], v1, s[40:43], s77 offen offset:2048 sc1
    buffer_load_dwordx4 v[100:103], v1, s[40:43], s77 offen offset:3072 sc1
    s_waitcnt vmcnt(0)
    v_mfma_f32_32x32x16_bf16 v[104:119], v[80:83], v[72:75], v[120:135]
    v_mfma_f32_32x32x16_bf16 v[104:119], v[84:87], v[76:79], v[104:119]
    s_nop 15
    v_exp_f32 v104, v104
    v_exp_f32 v105, v105
    v_exp_f32 v106, v106
    v_exp_f32 v107, v107
    v_exp_f32 v108, v108
    v_exp_f32 v109, v109
    v_exp_f32 v110, v110
    v_exp_f32 v111, v111
    v_exp_f32 v112, v112
    v_exp_f32 v113, v113
    v_exp_f32 v114, v114
    v_exp_f32 v115, v115
    v_exp_f32 v116, v116
    v_exp_f32 v117, v117
    v_exp_f32 v118, v118
    v_exp_f32 v119, v119
    s_nop 2
    v_smfmac_f32_32x32x32_bf16 v[152:167], v[96:99], v[104:111], v39
    v_smfmac_f32_32x32x32_bf16 v[152:167], v[100:103], v[112:119], v39
    v_smfmac_f32_16x16x64_bf16 v[44:47], v[48:51], v[104:111], v39
    v_smfmac_f32_16x16x64_bf16 v[44:47], v[48:51], v[112:119], v39
    s_add_u32 s77, s77, 4096
    s_cmp_lt_u32 s77, 327680
    s_cbranch_scc1 L_slow2_77
    s_nop 15
    s_branch L_slowr_67
L_hk_70:
    s_cmp_eq_u32 s70, 10
    s_cbranch_scc1 L_hn_79
    s_cmp_eq_u32 s70, 13
    s_cbranch_scc1 L_hn_80
L_hn_78:
    s_lshl4_add_u32 s77, s39, s3
    s_lshl2_add_u32 s77, s77, s38
    s_lshl2_add_u32 s77, s77, 4096
    s_waitcnt vmcnt(9)
    v_mov_b32 v1, 1
    s_mov_b64 exec, 1
    buffer_store_dword v1, off, s[40:43], s77 sc1
    s_mov_b64 exec, -1
    s_branch L_hkr_71
L_hn_79:
    buffer_load_dword v9, v8, s[40:43], s64 offen sc1
    s_branch L_hkr_71
L_hn_80:
    v_cmp_ne_u32 vcc, 1, v9
    s_mov_b64 s[100:101], -1
    s_and_b64 vcc, vcc, s[100:101]
    s_cbranch_scc1 L_spin_81
L_spinr_82:
    s_mov_b32 s48, s16
    s_mov_b32 s49, s17
    s_add_u32 s82, s82, 0x40000
    s_mov_b32 s72, 0
    s_branch L_hkr_71
L_spin_81:
    s_mov_b32 s76, 400000
L_sp_83:
    s_sleep 1
    buffer_load_dword v9, v8, s[40:43], s64 offen sc1
    s_waitcnt vmcnt(0)
    v_cmp_ne_u32 vcc, 1, v9
    s_mov_b64 s[100:101], -1
    s_and_b64 vcc, vcc, s[100:101]
    s_cbranch_scc0 L_spinr_82
    s_sub_u32 s76, s76, 1
    s_cmp_lg_u32 s76, 0
    s_cbranch_scc1 L_sp_83
    s_branch L_spinr_82
L_g2hi:
    s_lshl_b32 s73, s81, 12
    s_add_u32 s74, s73, 16384
    s_mov_b32 s75, 0x10000
    s_mov_b32 s82, 2
    v_mov_b32 v8, 0
    v_mov_b32 v10, 0
    s_mov_b32 s40, s36
    s_mov_b32 s41, s37
    s_mov_b32 s42, 0x10000000
    s_mov_b32 s43, 0x20000
    s_mov_b32 s56, s32
    s_mov_b32 s57, s33
    s_mov_b32 s58, 0x1000000
    s_mov_b32 s59, 0x20000
    s_mov_b32 s60, s34
    s_mov_b32 s61, s35
    s_mov_b32 s62, 0x100
    s_mov_b32 s63, 0x20000
    s_lshl_b32 s85, s81, 13
    v_lshl_add_u32 v63, v0, 4, s85
    v_add_u32 v62, 0x1000, v63
    s_mov_b32 s70, 0
L_lloop_84:
    s_xor_b32 s72, s82, s67
    s_lshl_b32 s71, s72, 17
    s_lshl_b32 s72, s72, 7
    s_add_u32 m0, s75, s73
    s_nop 0
    buffer_load_dwordx4 v52, s[48:51], s71 offen offset:0 lds
    buffer_load_dwordx4 v53, s[48:51], s71 offen offset:1024 lds
    s_waitcnt vmcnt(10)
    s_barrier
L_lloop_84_r:
    buffer_load_dwordx4 v54, s[48:51], s71 offen offset:2048 lds
    buffer_load_dwordx4 v55, s[48:51], s71 offen offset:3072 lds
    s_add_u32 m0, s75, s74
    s_nop 0
    buffer_load_dwordx4 v48, s[44:47], s72 offen offset:0 lds
    buffer_load_dwordx4 v49, s[44:47], s72 offen offset:1024 lds
    buffer_load_dwordx4 v50, s[44:47], s72 offen offset:2048 lds
    buffer_load_dwordx4 v51, s[44:47], s72 offen offset:3072 lds
    s_add_u32 s82, s82, 1
    s_add_u32 s75, s75, 0x8000
    s_and_b32 s75, s75, 0x1ffff
L_lloop0_85:
    s_bitcmp1_b32 6400, s70
    s_cbranch_scc1 L_hk_86
L_hkr_87:
    s_add_u32 s70, s70, 1
    s_cmp_lg_u32 s70, 14
    s_cbranch_scc1 L_lloop_84
    s_waitcnt vmcnt(9)
    s_barrier
    s_waitcnt vmcnt(8)
    v_and_b32 v12, v12, v13
    v_and_b32 v14, v14, v15
    v_and_b32 v12, v12, v14
    v_cmp_ne_u32 vcc, 1, v12
    s_mov_b64 s[100:101], -1
    s_and_b64 vcc, vcc, s[100:101]
    s_cbranch_scc1 L_spin_88
L_spinr_89:
    s_mov_b32 s80, 65536
    s_add_u32 m0, s85, 131072
    s_nop 0
    buffer_load_dwordx4 v63, s[40:43], s80 offen offset:0 sc1 lds
    buffer_load_dwordx4 v63, s[40:43], s80 offen offset:1024 sc1 lds
    buffer_load_dwordx4 v63, s[40:43], s80 offen offset:2048 sc1 lds
    buffer_load_dwordx4 v63, s[40:43], s80 offen offset:3072 sc1 lds
    s_add_u32 m0, s85, 135168
    s_nop 0
    buffer_load_dwordx4 v62, s[40:43], s80 offen offset:0 sc1 lds
    buffer_load_dwordx4 v62, s[40:43], s80 offen offset:1024 sc1 lds
    buffer_load_dwordx4 v62, s[40:43], s80 offen offset:2048 sc1 lds
    buffer_load_dwordx4 v62, s[40:43], s80 offen offset:3072 sc1 lds
    s_waitcnt vmcnt(8)
    s_barrier
    s_lshl_b32 s77, s81, 12
    v_lshl_add_u32 v52, v0, 4, s77
    s_lshl2_add_u32 s78, s3, s81
    s_lshl_b32 s78, s78, 5
    v_lshrrev_b32 v1, 3, v0
    v_and_b32 v2, 7, v0
    v_lshrrev_b32 v3, 1, v1
    v_xor_b32 v2, v2, v3
    v_add_lshl_u32 v1, v1, s78, 11
    v_lshl_add_u32 v53, v2, 4, v1
    v_xor_b32 v1, 64, v53
    v_add_u32 v54, 15360, v1
    v_add_u32 v55, 30720, v53
    v_add_u32 v56, 46080, v1
    s_mov_b32 s44, s4
    s_mov_b32 s45, s5
    s_mov_b32 s46, 0x400000
    s_mov_b32 s47, 0x20000
    s_mov_b32 s52, s16
    s_mov_b32 s53, s17
    s_mov_b32 s54, 0x200000
    s_mov_b32 s55, 0x20000
    s_and_b32 s78, s81, 1
    s_lshr_b32 s79, s81, 1
    s_lshl_b32 s77, s78, 13
    s_lshl1_add_u32 s80, s78, s79
    s_lshl_b32 s80, s80, 13
    v_and_b32 v1, 15, v0
    v_lshrrev_b32 v2, 4, v0
    v_bfe_u32 v3, v0, 1, 3
    v_xor_b32 v2, v2, v3
    v_lshlrev_b32 v2, 4, v2
    v_lshl_add_u32 v2, v1, 7, v2
    v_add_u32 v44, s80, v2
    v_xor_b32 v45, 64, v44
    v_add_u32 v40, s77, v2
    v_xor_b32 v41, 64, v40
    v_bfe_u32 v1, v0, 1, 1
    v_mul_u32_u24 v1, 1088, v1
    v_lshrrev_b32 v2, 5, v0
    v_lshl_add_u32 v1, v2, 12, v1
    v_bfe_u32 v2, v0, 4, 1
    v_lshl_add_u32 v1, v2, 7, v1
    v_bfe_u32 v2, v0, 2, 2
    v_lshl_add_u32 v1, v2, 4, v1
    v_and_b32 v2, 1, v0
    v_lshl_add_u32 v1, v2, 3, v1
    s_lshl_b32 s79, s79, 9
    s_add_u32 s79, s79, 16384
    v_add_u32 v42, s79, v1
    v_xor_b32 v43, 64, v42
    s_lshl1_add_u32 s78, s3, s78
    s_lshl_b32 s78, s78, 7
    v_and_b32 v1, 15, v0
    v_lshl_add_u32 v1, v1, 1, s78
    global_load_ushort v58, v1, s[20:21] offset:0
    global_load_ushort v59, v1, s[20:21] offset:32
    global_load_ushort v60, v1, s[20:21] offset:64
    global_load_ushort v61, v1, s[20:21] offset:96
    s_waitcnt vmcnt(4)
    s_barrier
    s_setprio 1
    s_lshr_b32 s78, s81, 1
    s_lshl1_add_u32 s77, s39, s78
    s_lshl_b32 s77, s77, 19
    s_and_b32 s78, s81, 1
    s_lshl1_add_u32 s78, s3, s78
    s_lshl_b32 s78, s78, 8
    s_add_u32 s77, s77, s78
    s_add_u32 s64, s77, 0
    s_add_u32 s65, s77, 131072
    s_add_u32 s66, s77, 262144
    s_add_u32 s67, s77, 393216
    s_lshl_b32 s77, s81, 13
    s_add_u32 s77, s77, 131072
    v_and_b32 v46, 15, v0
    v_and_b32 v1, 48, v0
    v_mul_u32_u24 v32, 272, v46
    v_add3_u32 v32, v32, v1, s77
    v_lshlrev_b32 v46, 4, v46
    v_mul_u32_u24 v33, 17, v1
    v_add3_u32 v33, v33, v46, s77
    v_lshl_add_u32 v46, v1, 9, v46
    v_lshlrev_b32 v2, 4, v2
    v_lshrrev_b32 v1, 4, v0
    v_bfe_u32 v3, v0, 1, 3
    v_lshlrev_b32 v1, 2, v1
    v_sub_u32 v3, v3, v1
    s_waitcnt vmcnt(0)
    v_lshlrev_b32 v58, v2, v58
    v_lshlrev_b32 v59, v2, v59
    v_lshlrev_b32 v60, v2, v60
    v_lshlrev_b32 v61, v2, v61
    v_cmp_eq_u32 vcc, 0, v3
    v_cmp_eq_u32 s[100:101], -8, v3
    s_nop 0
    v_cndmask_b32 v160, 0, v58, vcc
    v_cndmask_b32 v168, 0, v60, vcc
    v_cndmask_b32 v164, 0, v59, s[100:101]
    v_cndmask_b32 v172, 0, v61, s[100:101]
    v_cmp_eq_u32 vcc, 1, v3
    v_cmp_eq_u32 s[100:101], -7, v3
    s_nop 0
    v_cndmask_b32 v161, 0, v58, vcc
    v_cndmask_b32 v169, 0, v60, vcc
    v_cndmask_b32 v165, 0, v59, s[100:101]
    v_cndmask_b32 v173, 0, v61, s[100:101]
    v_cmp_eq_u32 vcc, 2, v3
    v_cmp_eq_u32 s[100:101], -6, v3
    s_nop 0
    v_cndmask_b32 v162, 0, v58, vcc
    v_cndmask_b32 v170, 0, v60, vcc
    v_cndmask_b32 v166, 0, v59, s[100:101]
    v_cndmask_b32 v174, 0, v61, s[100:101]
    v_cmp_eq_u32 vcc, 3, v3
    v_cmp_eq_u32 s[100:101], -5, v3
    s_nop 0
    v_cndmask_b32 v163, 0, v58, vcc
    v_cndmask_b32 v171, 0, v60, vcc
    v_cndmask_b32 v167, 0, v59, s[100:101]
    v_cndmask_b32 v175, 0, v61, s[100:101]
    s_barrier
    s_mov_b32 s80, 98304
    s_add_u32 m0, s85, 98304
    s_nop 0
    buffer_load_dwordx4 v63, s[40:43], s80 offen offset:0 sc1 lds
    buffer_load_dwordx4 v63, s[40:43], s80 offen offset:1024 sc1 lds
    buffer_load_dwordx4 v63, s[40:43], s80 offen offset:2048 sc1 lds
    buffer_load_dwordx4 v63, s[40:43], s80 offen offset:3072 sc1 lds
    s_add_u32 m0, s85, 102400
    s_nop 0
    buffer_load_dwordx4 v62, s[40:43], s80 offen offset:0 sc1 lds
    buffer_load_dwordx4 v62, s[40:43], s80 offen offset:1024 sc1 lds
    buffer_load_dwordx4 v62, s[40:43], s80 offen offset:2048 sc1 lds
    buffer_load_dwordx4 v62, s[40:43], s80 offen offset:3072 sc1 lds
    s_lshl_b32 s71, s3, 8
    s_add_u32 s72, s71, 128
    s_add_u32 m0, s75, s73
    s_nop 0
    buffer_load_dwordx4 v48, s[44:47], s71 offen offset:0 lds
    buffer_load_dwordx4 v49, s[44:47], s71 offen offset:1024 lds
    buffer_load_dwordx4 v50, s[44:47], s71 offen offset:2048 lds
    buffer_load_dwordx4 v51, s[44:47], s71 offen offset:3072 lds
    s_add_u32 m0, s75, s74
    s_nop 0
    buffer_load_dwordx4 v48, s[44:47], s72 offen offset:0 lds
    buffer_load_dwordx4 v49, s[44:47], s72 offen offset:1024 lds
    buffer_load_dwordx4 v50, s[44:47], s72 offen offset:2048 lds
    buffer_load_dwordx4 v51, s[44:47], s72 offen offset:3072 lds
    s_mov_b32 s79, 0x200000
    s_lshl3_add_u32 s77, s39, s3
    s_lshl2_add_u32 s77, s77, s81
    s_cmp_lt_u32 s77, 0x180
    s_cselect_b64 s[48:49], s[10:11], s[12:13]
    s_cmp_lt_u32 s77, 0x100
    s_cselect_b64 s[48:49], s[4:5], s[48:49]
    s_cselect_b32 s50, 0x400000, s79
    s_mov_b32 s51, 0x20000
    s_movk_i32 s78, 0x7f
    s_cmov_b32 s78, 0xff
    s_and_b32 s77, s77, s78
    s_lshl_b32 s77, s77, 14
    v_bfe_u32 v1, v0, 2, 3
    v_and_b32 v2, 3, v0
    v_lshl_add_u32 v1, v1, 4, v2
    v_lshl_add_u32 v30, v1, 7, s77
    buffer_load_dword v7, v30, s[48:51], 0 offen offset:1536
    s_mov_b32 s48, s14
    s_mov_b32 s49, s15
    s_mov_b32 s50, 0x200000
    s_mov_b32 s51, 0x20000
    s_lshl_b32 s82, s39, 19
    s_add_u32 s82, s82, 8388608
    s_lshl_b32 s72, s3, 8
    s_add_u32 s72, s72, 0
    s_and_b32 s72, s72, 2047
    s_mov_b32 s75, 0
    s_waitcnt vmcnt(1)
    s_barrier
    s_cmp_lg_u32 s38, 4
    s_cbranch_scc1 L_sk_90
    s_lshl3_add_u32 s77, s39, s3
    s_lshl2_add_u32 s77, s77, 1024
    v_mov_b32 v1, 1
    s_mov_b64 exec, 1
    buffer_store_dword v1, off, s[40:43], s77 sc1
    s_mov_b64 exec, -1
L_sk_90:
    ds_read_b128 v[128:131], v44 offset:0
    ds_read_b128 v[132:135], v44 offset:2048
    ds_read_b128 v[136:139], v44 offset:4096
    ds_read_b128 v[140:143], v44 offset:6144
    ds_read_b128 v[144:147], v45 offset:0
    ds_read_b128 v[148:151], v45 offset:2048
    ds_read_b128 v[152:155], v45 offset:4096
    ds_read_b128 v[156:159], v45 offset:6144
    s_mov_b32 s80, 131072
    s_add_u32 m0, s85, 65536
    s_nop 0
    buffer_load_dwordx4 v63, s[40:43], s80 offen offset:0 sc1 lds
    buffer_load_dwordx4 v63, s[40:43], s80 offen offset:1024 sc1 lds
    buffer_load_dwordx4 v63, s[40:43], s80 offen offset:2048 sc1 lds
    buffer_load_dwordx4 v63, s[40:43], s80 offen offset:3072 sc1 lds
    s_add_u32 m0, s85, 69632
    s_nop 0
    buffer_load_dwordx4 v62, s[40:43], s80 offen offset:0 sc1 lds
    buffer_load_dwordx4 v62, s[40:43], s80 offen offset:1024 sc1 lds
    buffer_load_dwordx4 v62, s[40:43], s80 offen offset:2048 sc1 lds
    buffer_load_dwordx4 v62, s[40:43], s80 offen offset:3072 sc1 lds
    s_lshr_b32 s78, s39, 2
    s_lshl_b32 s78, s78, 19
    s_lshl2_add_u32 s77, s83, s81
    s_lshl_b32 s77, s77, 12
    s_add_u32 s77, s77, s78
    v_and_b32 v1, 31, v0
    v_lshlrev_b32 v1, 7, v1
    buffer_load_dword v7, v1, s[52:55], s77 offen
    s_waitcnt lgkmcnt(0)
    v_mfma_f32_16x16x32_bf16 v[192:195], v[160:163], v[128:131], 0
    v_mfma_f32_16x16x32_bf16 v[196:199], v[160:163], v[132:135], 0
    v_mfma_f32_16x16x32_bf16 v[200:203], v[160:163], v[136:139], 0
    v_mfma_f32_16x16x32_bf16 v[204:207], v[160:163], v[140:143], 0
    v_mfma_f32_16x16x32_bf16 v[208:211], v[164:167], v[128:131], 0
    v_mfma_f32_16x16x32_bf16 v[212:215], v[164:167], v[132:135], 0
    v_mfma_f32_16x16x32_bf16 v[216:219], v[164:167], v[136:139], 0
    v_mfma_f32_16x16x32_bf16 v[220:223], v[164:167], v[140:143], 0
    v_mfma_f32_16x16x32_bf16 v[224:227], v[168:171], v[144:147], 0
    v_mfma_f32_16x16x32_bf16 v[228:231], v[168:171], v[148:151], 0
    v_mfma_f32_16x16x32_bf16 v[232:235], v[168:171], v[152:155], 0
    v_mfma_f32_16x16x32_bf16 v[236:239], v[168:171], v[156:159], 0
    v_mfma_f32_16x16x32_bf16 v[240:243], v[172:175], v[144:147], 0
    v_mfma_f32_16x16x32_bf16 v[244:247], v[172:175], v[148:151], 0
    v_mfma_f32_16x16x32_bf16 v[248:251], v[172:175], v[152:155], 0
    v_mfma_f32_16x16x32_bf16 v[252:255], v[172:175], v[156:159], 0
    s_waitcnt vmcnt(1)
    s_barrier
    s_mov_b32 s80, 163840
    s_add_u32 m0, s85, 131072
    s_nop 0
    buffer_load_dwordx4 v63, s[40:43], s80 offen offset:0 sc1 lds
    buffer_load_dwordx4 v63, s[40:43], s80 offen offset:1024 sc1 lds
    buffer_load_dwordx4 v63, s[40:43], s80 offen offset:2048 sc1 lds
    buffer_load_dwordx4 v63, s[40:43], s80 offen offset:3072 sc1 lds
    s_add_u32 m0, s85, 135168
    s_nop 0
    buffer_load_dwordx4 v62, s[40:43], s80 offen offset:0 sc1 lds
    buffer_load_dwordx4 v62, s[40:43], s80 offen offset:1024 sc1 lds
    buffer_load_dwordx4 v62, s[40:43], s80 offen offset:2048 sc1 lds
    buffer_load_dwordx4 v62, s[40:43], s80 offen offset:3072 sc1 lds
    s_lshl2_add_u32 s77, s83, s81
    s_lshl_b32 s77, s77, 12
    v_and_b32 v1, 31, v0
    v_lshlrev_b32 v1, 7, v1
    buffer_load_dword v7, v1, s[48:51], s77 offen
    s_waitcnt vmcnt(1)
    s_barrier
    s_mov_b32 s80, 196608
    s_add_u32 m0, s85, 98304
    s_nop 0
    buffer_load_dwordx4 v63, s[40:43], s80 offen offset:0 sc1 lds
    buffer_load_dwordx4 v63, s[40:43], s80 offen offset:1024 sc1 lds
    buffer_load_dwordx4 v63, s[40:43], s80 offen offset:2048 sc1 lds
    buffer_load_dwordx4 v63, s[40:43], s80 offen offset:3072 sc1 lds
    s_add_u32 m0, s85, 102400
    s_nop 0
    buffer_load_dwordx4 v62, s[40:43], s80 offen offset:0 sc1 lds
    buffer_load_dwordx4 v62, s[40:43], s80 offen offset:1024 sc1 lds
    buffer_load_dwordx4 v62, s[40:43], s80 offen offset:2048 sc1 lds
    buffer_load_dwordx4 v62, s[40:43], s80 offen offset:3072 sc1 lds
    s_lshl2_add_u32 s77, s83, s81
    s_lshl_b32 s77, s77, 12
    s_add_u32 s77, s77, 524288
    v_and_b32 v1, 31, v0
    v_lshlrev_b32 v1, 7, v1
    buffer_load_dword v7, v1, s[48:51], s77 offen
    s_waitcnt vmcnt(1)
    s_barrier
    s_mov_b32 s80, 229376
    s_add_u32 m0, s85, 65536
    s_nop 0
    buffer_load_dwordx4 v63, s[40:43], s80 offen offset:0 sc1 lds
    buffer_load_dwordx4 v63, s[40:43], s80 offen offset:1024 sc1 lds
    buffer_load_dwordx4 v63, s[40:43], s80 offen offset:2048 sc1 lds
    buffer_load_dwordx4 v63, s[40:43], s80 offen offset:3072 sc1 lds
    s_add_u32 m0, s85, 69632
    s_nop 0
    buffer_load_dwordx4 v62, s[40:43], s80 offen offset:0 sc1 lds
    buffer_load_dwordx4 v62, s[40:43], s80 offen offset:1024 sc1 lds
    buffer_load_dwordx4 v62, s[40:43], s80 offen offset:2048 sc1 lds
    buffer_load_dwordx4 v62, s[40:43], s80 offen offset:3072 sc1 lds
    s_lshl2_add_u32 s77, s83, s81
    s_lshl_b32 s77, s77, 12
    s_add_u32 s77, s77, 1048576
    v_and_b32 v1, 31, v0
    v_lshlrev_b32 v1, 7, v1
    buffer_load_dword v7, v1, s[48:51], s77 offen
    s_waitcnt vmcnt(1)
    s_barrier
    s_mov_b32 s80, 262144
    s_add_u32 m0, s85, 131072
    s_nop 0
    buffer_load_dwordx4 v63, s[40:43], s80 offen offset:0 sc1 lds
    buffer_load_dwordx4 v63, s[40:43], s80 offen offset:1024 sc1 lds
    buffer_load_dwordx4 v63, s[40:43], s80 offen offset:2048 sc1 lds
    buffer_load_dwordx4 v63, s[40:43], s80 offen offset:3072 sc1 lds
    s_add_u32 m0, s85, 135168
    s_nop 0
    buffer_load_dwordx4 v62, s[40:43], s80 offen offset:0 sc1 lds
    buffer_load_dwordx4 v62, s[40:43], s80 offen offset:1024 sc1 lds
    buffer_load_dwordx4 v62, s[40:43], s80 offen offset:2048 sc1 lds
    buffer_load_dwordx4 v62, s[40:43], s80 offen offset:3072 sc1 lds
    s_lshl2_add_u32 s77, s83, s81
    s_lshl_b32 s77, s77, 12
    s_add_u32 s77, s77, 1572864
    v_and_b32 v1, 31, v0
    v_lshlrev_b32 v1, 7, v1
    buffer_load_dword v7, v1, s[48:51], s77 offen
    s_waitcnt vmcnt(1)
    s_barrier
    s_mov_b32 s80, 294912
    s_add_u32 m0, s85, 98304
    s_nop 0
    buffer_load_dwordx4 v63, s[40:43], s80 offen offset:0 sc1 lds
    buffer_load_dwordx4 v63, s[40:43], s80 offen offset:1024 sc1 lds
    buffer_load_dwordx4 v63, s[40:43], s80 offen offset:2048 sc1 lds
    buffer_load_dwordx4 v63, s[40:43], s80 offen offset:3072 sc1 lds
    s_add_u32 m0, s85, 102400
    s_nop 0
    buffer_load_dwordx4 v62, s[40:43], s80 offen offset:0 sc1 lds
    buffer_load_dwordx4 v62, s[40:43], s80 offen offset:1024 sc1 lds
    buffer_load_dwordx4 v62, s[40:43], s80 offen offset:2048 sc1 lds
    buffer_load_dwordx4 v62, s[40:43], s80 offen offset:3072 sc1 lds
    s_waitcnt vmcnt(0)
    s_barrier
    s_lshr_b32 s77, s39, 1
    s_lshl_b32 s77, s77, 8
    s_add_u32 s77, s77, 2048
    v_lshlrev_b32 v8, 2, v0
    buffer_load_dword v9, v8, s[40:43], s77 offen sc1
    s_waitcnt vmcnt(0)
    v_cmp_ne_u32 vcc, 1, v9
    s_mov_b64 s[100:101], -1
    s_and_b64 vcc, vcc, s[100:101]
    s_cbranch_scc1 L_spin_91
L_spinr_92:
L_pre_93:
    s_lshl_b32 s71, s72, 7
    s_add_u32 s71, s71, s82
    s_add_u32 m0, s75, s73
    s_nop 0
    buffer_load_dwordx4 v53, s[48:51], s72 offen offset:0 lds
    buffer_load_dwordx4 v54, s[48:51], s72 offen offset:1024 lds
    buffer_load_dwordx4 v55, s[48:51], s72 offen offset:2048 lds
    buffer_load_dwordx4 v56, s[48:51], s72 offen offset:3072 lds
    s_add_u32 m0, s75, s74
    s_nop 0
    buffer_load_dwordx4 v52, s[40:43], s71 offen offset:0 sc1 lds
    buffer_load_dwordx4 v52, s[40:43], s71 offen offset:1024 sc1 lds
    buffer_load_dwordx4 v52, s[40:43], s71 offen offset:2048 sc1 lds
    buffer_load_dwordx4 v52, s[40:43], s71 offen offset:3072 sc1 lds
    s_add_u32 s72, s72, 128
    s_and_b32 s72, s72, 2047
    s_add_u32 s75, s75, 0x8000
    s_and_b32 s75, s75, 0x1ffff
    s_cmp_lg_u32 s75, 0x18000
    s_cbranch_scc1 L_pre_93
    s_setprio 0
    s_waitcnt vmcnt(0)
    s_barrier
    ds_read_b128 v[64:67], v40 offset:0
    ds_read_b128 v[68:71], v41 offset:0
    ds_read_b64_tr_b16 v[96:97], v42 offset:0
    ds_read_b64_tr_b16 v[98:99], v43 offset:0
    ds_read_b64_tr_b16 v[100:101], v42 offset:8192
    ds_read_b64_tr_b16 v[102:103], v43 offset:8192
    ds_read_b64_tr_b16 v[104:105], v42 offset:2048
    ds_read_b64_tr_b16 v[106:107], v43 offset:2048
    ds_read_b64_tr_b16 v[108:109], v42 offset:10240
    ds_read_b64_tr_b16 v[110:111], v43 offset:10240
    ds_read_b64_tr_b16 v[112:113], v42 offset:256
    ds_read_b64_tr_b16 v[114:115], v43 offset:256
    ds_read_b64_tr_b16 v[116:117], v42 offset:8448
    ds_read_b64_tr_b16 v[118:119], v43 offset:8448
    ds_read_b64_tr_b16 v[120:121], v42 offset:2304
    ds_read_b64_tr_b16 v[122:123], v43 offset:2304
    ds_read_b64_tr_b16 v[124:125], v42 offset:10496
    ds_read_b64_tr_b16 v[126:127], v43 offset:10496
    ds_read_b128 v[72:75], v40 offset:2048
    ds_read_b128 v[76:79], v41 offset:2048
    ds_read_b128 v[80:83], v40 offset:4096
    ds_read_b128 v[84:87], v41 offset:4096
    ds_read_b128 v[88:91], v40 offset:6144
    ds_read_b128 v[92:95], v41 offset:6144
    s_mov_b32 s70, 0
    .p2align 3
L_gloop_94:
    s_waitcnt lgkmcnt(0)
    v_mfma_f32_16x16x32_bf16 v[192:195], v[64:67], v[96:99], v[192:195]
    s_barrier
    v_mfma_f32_16x16x32_bf16 v[192:195], v[68:71], v[100:103], v[192:195]
    ds_read_b128 v[128:131], v40 offset:32768
    v_mfma_f32_16x16x32_bf16 v[196:199], v[64:67], v[104:107], v[196:199]
    ds_read_b128 v[132:135], v41 offset:32768
    v_mfma_f32_16x16x32_bf16 v[196:199], v[68:71], v[108:111], v[196:199]
    ds_read_b64_tr_b16 v[160:161], v42 offset:32768
    v_mfma_f32_16x16x32_bf16 v[200:203], v[64:67], v[112:115], v[200:203]
    ds_read_b64_tr_b16 v[162:163], v43 offset:32768
    v_mfma_f32_16x16x32_bf16 v[200:203], v[68:71], v[116:119], v[200:203]
    ds_read_b64_tr_b16 v[164:165], v42 offset:40960
    v_mfma_f32_16x16x32_bf16 v[204:207], v[64:67], v[120:123], v[204:207]
    ds_read_b64_tr_b16 v[166:167], v43 offset:40960
    v_mfma_f32_16x16x32_bf16 v[204:207], v[68:71], v[124:127], v[204:207]
    ds_read_b64_tr_b16 v[168:169], v42 offset:34816
    v_mfma_f32_16x16x32_bf16 v[220:223], v[72:75], v[120:123], v[220:223]
    ds_read_b64_tr_b16 v[170:171], v43 offset:34816
    v_mfma_f32_16x16x32_bf16 v[220:223], v[76:79], v[124:127], v[220:223]
    ds_read_b64_tr_b16 v[172:173], v42 offset:43008
    v_mfma_f32_16x16x32_bf16 v[216:219], v[72:75], v[112:115], v[216:219]
    ds_read_b64_tr_b16 v[174:175], v43 offset:43008
    v_mfma_f32_16x16x32_bf16 v[216:219], v[76:79], v[116:119], v[216:219]
    ds_read_b64_tr_b16 v[176:177], v42 offset:33024
    v_mfma_f32_16x16x32_bf16 v[212:215], v[72:75], v[104:107], v[212:215]
    ds_read_b64_tr_b16 v[178:179], v43 offset:33024
    v_mfma_f32_16x16x32_bf16 v[212:215], v[76:79], v[108:111], v[212:215]
    ds_read_b64_tr_b16 v[180:181], v42 offset:41216
    v_mfma_f32_16x16x32_bf16 v[208:211], v[72:75], v[96:99], v[208:211]
    ds_read_b64_tr_b16 v[182:183], v43 offset:41216
    v_mfma_f32_16x16x32_bf16 v[208:211], v[76:79], v[100:103], v[208:211]
    ds_read_b64_tr_b16 v[184:185], v42 offset:35072
    v_mfma_f32_16x16x32_bf16 v[224:227], v[80:83], v[96:99], v[224:227]
    ds_read_b64_tr_b16 v[186:187], v43 offset:35072
    v_mfma_f32_16x16x32_bf16 v[224:227], v[84:87], v[100:103], v[224:227]
    ds_read_b64_tr_b16 v[188:189], v42 offset:43264
    v_mfma_f32_16x16x32_bf16 v[228:231], v[80:83], v[104:107], v[228:231]
    ds_read_b64_tr_b16 v[190:191], v43 offset:43264
    v_mfma_f32_16x16x32_bf16 v[228:231], v[84:87], v[108:111], v[228:231]
    ds_read_b128 v[136:139], v40 offset:34816
    v_mfma_f32_16x16x32_bf16 v[232:235], v[80:83], v[112:115], v[232:235]
    ds_read_b128 v[140:143], v41 offset:34816
    v_mfma_f32_16x16x32_bf16 v[232:235], v[84:87], v[116:119], v[232:235]
    ds_read_b128 v[144:147], v40 offset:36864
    v_mfma_f32_16x16x32_bf16 v[236:239], v[80:83], v[120:123], v[236:239]
    ds_read_b128 v[148:151], v41 offset:36864
    v_mfma_f32_16x16x32_bf16 v[236:239], v[84:87], v[124:127], v[236:239]
    ds_read_b128 v[152:155], v40 offset:38912
    v_mfma_f32_16x16x32_bf16 v[252:255], v[88:91], v[120:123], v[252:255]
    ds_read_b128 v[156:159], v41 offset:38912
    v_mfma_f32_16x16x32_bf16 v[252:255], v[92:95], v[124:127], v[252:255]
    v_xor_b32 v40, 0x10000, v40
    v_mfma_f32_16x16x32_bf16 v[248:251], v[88:91], v[112:115], v[248:251]
    v_xor_b32 v41, 0x10000, v41
    v_mfma_f32_16x16x32_bf16 v[248:251], v[92:95], v[116:119], v[248:251]
    v_xor_b32 v42, 0x10000, v42
    v_mfma_f32_16x16x32_bf16 v[244:247], v[88:91], v[104:107], v[244:247]
    v_xor_b32 v43, 0x10000, v43
    v_mfma_f32_16x16x32_bf16 v[244:247], v[92:95], v[108:111], v[244:247]
    v_mfma_f32_16x16x32_bf16 v[240:243], v[88:91], v[96:99], v[240:243]
    v_mfma_f32_16x16x32_bf16 v[240:243], v[92:95], v[100:103], v[240:243]
    s_waitcnt lgkmcnt(0)
    v_mfma_f32_16x16x32_bf16 v[192:195], v[128:131], v[160:163], v[192:195]
    s_barrier
    v_mfma_f32_16x16x32_bf16 v[192:195], v[132:135], v[164:167], v[192:195]
    ds_read_b128 v[64:67], v40 offset:0
    v_mfma_f32_16x16x32_bf16 v[196:199], v[128:131], v[168:171], v[196:199]
    ds_read_b128 v[68:71], v41 offset:0
    v_mfma_f32_16x16x32_bf16 v[196:199], v[132:135], v[172:175], v[196:199]
    ds_read_b64_tr_b16 v[96:97], v42 offset:0
    v_mfma_f32_16x16x32_bf16 v[200:203], v[128:131], v[176:179], v[200:203]
    ds_read_b64_tr_b16 v[98:99], v43 offset:0
    v_mfma_f32_16x16x32_bf16 v[200:203], v[132:135], v[180:183], v[200:203]
    ds_read_b64_tr_b16 v[100:101], v42 offset:8192
    v_mfma_f32_16x16x32_bf16 v[204:207], v[128:131], v[184:187], v[204:207]
    ds_read_b64_tr_b16 v[102:103], v43 offset:8192
    v_mfma_f32_16x16x32_bf16 v[204:207], v[132:135], v[188:191], v[204:207]
    ds_read_b64_tr_b16 v[104:105], v42 offset:2048
    v_mfma_f32_16x16x32_bf16 v[220:223], v[136:139], v[184:187], v[220:223]
    ds_read_b64_tr_b16 v[106:107], v43 offset:2048
    v_mfma_f32_16x16x32_bf16 v[220:223], v[140:143], v[188:191], v[220:223]
    ds_read_b64_tr_b16 v[108:109], v42 offset:10240
    v_mfma_f32_16x16x32_bf16 v[216:219], v[136:139], v[176:179], v[216:219]
    ds_read_b64_tr_b16 v[110:111], v43 offset:10240
    v_mfma_f32_16x16x32_bf16 v[216:219], v[140:143], v[180:183], v[216:219]
    ds_read_b64_tr_b16 v[112:113], v42 offset:256
    v_mfma_f32_16x16x32_bf16 v[212:215], v[136:139], v[168:171], v[212:215]
    ds_read_b64_tr_b16 v[114:115], v43 offset:256
    v_mfma_f32_16x16x32_bf16 v[212:215], v[140:143], v[172:175], v[212:215]
    ds_read_b64_tr_b16 v[116:117], v42 offset:8448
    v_mfma_f32_16x16x32_bf16 v[208:211], v[136:139], v[160:163], v[208:211]
    ds_read_b64_tr_b16 v[118:119], v43 offset:8448
    v_mfma_f32_16x16x32_bf16 v[208:211], v[140:143], v[164:167], v[208:211]
    ds_read_b64_tr_b16 v[120:121], v42 offset:2304
    v_mfma_f32_16x16x32_bf16 v[224:227], v[144:147], v[160:163], v[224:227]
    ds_read_b64_tr_b16 v[122:123], v43 offset:2304
    v_mfma_f32_16x16x32_bf16 v[224:227], v[148:151], v[164:167], v[224:227]
    ds_read_b64_tr_b16 v[124:125], v42 offset:10496
    v_mfma_f32_16x16x32_bf16 v[228:231], v[144:147], v[168:171], v[228:231]
    ds_read_b64_tr_b16 v[126:127], v43 offset:10496
    v_mfma_f32_16x16x32_bf16 v[228:231], v[148:151], v[172:175], v[228:231]
    ds_read_b128 v[72:75], v40 offset:2048
    v_mfma_f32_16x16x32_bf16 v[232:235], v[144:147], v[176:179], v[232:235]
    ds_read_b128 v[76:79], v41 offset:2048
    v_mfma_f32_16x16x32_bf16 v[232:235], v[148:151], v[180:183], v[232:235]
    ds_read_b128 v[80:83], v40 offset:4096
    v_mfma_f32_16x16x32_bf16 v[236:239], v[144:147], v[184:187], v[236:239]
    ds_read_b128 v[84:87], v41 offset:4096
    v_mfma_f32_16x16x32_bf16 v[236:239], v[148:151], v[188:191], v[236:239]
    ds_read_b128 v[88:91], v40 offset:6144
    v_mfma_f32_16x16x32_bf16 v[252:255], v[152:155], v[184:187], v[252:255]
    ds_read_b128 v[92:95], v41 offset:6144
    v_mfma_f32_16x16x32_bf16 v[252:255], v[156:159], v[188:191], v[252:255]
    s_add_u32 s70, s70, 1
    v_mfma_f32_16x16x32_bf16 v[248:251], v[152:155], v[176:179], v[248:251]
    s_cmp_lg_u32 s70, 15
    v_mfma_f32_16x16x32_bf16 v[248:251], v[156:159], v[180:183], v[248:251]
    v_mfma_f32_16x16x32_bf16 v[244:247], v[152:155], v[168:171], v[244:247]
    v_mfma_f32_16x16x32_bf16 v[244:247], v[156:159], v[172:175], v[244:247]
    v_mfma_f32_16x16x32_bf16 v[240:243], v[152:155], v[160:163], v[240:243]
    v_mfma_f32_16x16x32_bf16 v[240:243], v[156:159], v[164:167], v[240:243]
    s_cbranch_scc1 L_gloop_94
    s_waitcnt lgkmcnt(0)
    v_mfma_f32_16x16x32_bf16 v[192:195], v[64:67], v[96:99], v[192:195]
    s_barrier
    v_mfma_f32_16x16x32_bf16 v[192:195], v[68:71], v[100:103], v[192:195]
    ds_read_b128 v[128:131], v40 offset:32768
    v_mfma_f32_16x16x32_bf16 v[208:211], v[72:75], v[96:99], v[208:211]
    ds_read_b128 v[132:135], v41 offset:32768
    v_mfma_f32_16x16x32_bf16 v[208:211], v[76:79], v[100:103], v[208:211]
    ds_read_b128 v[136:139], v40 offset:34816
    v_mfma_f32_16x16x32_bf16 v[224:227], v[80:83], v[96:99], v[224:227]
    ds_read_b128 v[140:143], v41 offset:34816
    v_mfma_f32_16x16x32_bf16 v[224:227], v[84:87], v[100:103], v[224:227]
    ds_read_b128 v[144:147], v40 offset:36864
    v_mfma_f32_16x16x32_bf16 v[240:243], v[88:91], v[96:99], v[240:243]
    ds_read_b128 v[148:151], v41 offset:36864
    v_mfma_f32_16x16x32_bf16 v[240:243], v[92:95], v[100:103], v[240:243]
    ds_read_b128 v[152:155], v40 offset:38912
    v_mfma_f32_16x16x32_bf16 v[196:199], v[64:67], v[104:107], v[196:199]
    ds_read_b128 v[156:159], v41 offset:38912
    v_mfma_f32_16x16x32_bf16 v[196:199], v[68:71], v[108:111], v[196:199]
    ds_read_b64_tr_b16 v[160:161], v42 offset:32768
    v_mfma_f32_16x16x32_bf16 v[212:215], v[72:75], v[104:107], v[212:215]
    ds_read_b64_tr_b16 v[162:163], v43 offset:32768
    v_mfma_f32_16x16x32_bf16 v[212:215], v[76:79], v[108:111], v[212:215]
    ds_read_b64_tr_b16 v[164:165], v42 offset:40960
    v_mfma_f32_16x16x32_bf16 v[228:231], v[80:83], v[104:107], v[228:231]
    ds_read_b64_tr_b16 v[166:167], v43 offset:40960
    v_mfma_f32_16x16x32_bf16 v[228:231], v[84:87], v[108:111], v[228:231]
    ds_read_b64_tr_b16 v[168:169], v42 offset:34816
    v_mfma_f32_16x16x32_bf16 v[244:247], v[88:91], v[104:107], v[244:247]
    ds_read_b64_tr_b16 v[170:171], v43 offset:34816
    v_mfma_f32_16x16x32_bf16 v[244:247], v[92:95], v[108:111], v[244:247]
    ds_read_b64_tr_b16 v[172:173], v42 offset:43008
    s_waitcnt lgkmcnt(3)
    v_mfma_f32_16x16x32_bf16 v[192:195], v[128:131], v[160:163], v[192:195]
    ds_read_b64_tr_b16 v[174:175], v43 offset:43008
    v_mfma_f32_16x16x32_bf16 v[192:195], v[132:135], v[164:167], v[192:195]
    ds_read_b64_tr_b16 v[176:177], v42 offset:33024
    v_mfma_f32_16x16x32_bf16 v[208:211], v[136:139], v[160:163], v[208:211]
    ds_read_b64_tr_b16 v[178:179], v43 offset:33024
    v_mfma_f32_16x16x32_bf16 v[208:211], v[140:143], v[164:167], v[208:211]
    ds_read_b64_tr_b16 v[180:181], v42 offset:41216
    v_mfma_f32_16x16x32_bf16 v[224:227], v[144:147], v[160:163], v[224:227]
    ds_read_b64_tr_b16 v[182:183], v43 offset:41216
    v_mfma_f32_16x16x32_bf16 v[224:227], v[148:151], v[164:167], v[224:227]
    ds_read_b64_tr_b16 v[184:185], v42 offset:35072
    v_mfma_f32_16x16x32_bf16 v[240:243], v[152:155], v[160:163], v[240:243]
    ds_read_b64_tr_b16 v[186:187], v43 offset:35072
    v_mfma_f32_16x16x32_bf16 v[240:243], v[156:159], v[164:167], v[240:243]
    ds_read_b64_tr_b16 v[188:189], v42 offset:43264
    s_waitcnt lgkmcnt(7)
    v_mfma_f32_16x16x32_bf16 v[196:199], v[128:131], v[168:171], v[196:199]
    ds_read_b64_tr_b16 v[190:191], v43 offset:43264
    v_mfma_f32_16x16x32_bf16 v[196:199], v[132:135], v[172:175], v[196:199]
    ds_write_b128 v32, v[192:195] offset:0
    v_mfma_f32_16x16x32_bf16 v[212:215], v[136:139], v[168:171], v[212:215]
    ds_write_b128 v32, v[208:211] offset:64
    v_mfma_f32_16x16x32_bf16 v[212:215], v[140:143], v[172:175], v[212:215]
    ds_write_b128 v32, v[224:227] offset:128
    v_mfma_f32_16x16x32_bf16 v[228:231], v[144:147], v[168:171], v[228:231]
    ds_write_b128 v32, v[240:243] offset:192
    ds_read_b128 v[192:195], v33 offset:0
    v_mfma_f32_16x16x32_bf16 v[228:231], v[148:151], v[172:175], v[228:231]
    ds_read_b128 v[208:211], v33 offset:1088
    ds_read_b128 v[224:227], v33 offset:2176
    v_mfma_f32_16x16x32_bf16 v[244:247], v[152:155], v[168:171], v[244:247]
    ds_read_b128 v[240:243], v33 offset:3264
    v_mfma_f32_16x16x32_bf16 v[244:247], v[156:159], v[172:175], v[244:247]
    s_waitcnt lgkmcnt(3)
    buffer_store_dwordx4 v[192:195], v46, s[56:59], s64 offen sc1
    s_add_u32 s64, s64, 0x8000
    v_mfma_f32_16x16x32_bf16 v[200:203], v[64:67], v[112:115], v[200:203]
    s_waitcnt lgkmcnt(2)
    buffer_store_dwordx4 v[208:211], v46, s[56:59], s64 offen sc1
    s_add_u32 s64, s64, 0x8000
    v_mfma_f32_16x16x32_bf16 v[200:203], v[68:71], v[116:119], v[200:203]
    ds_write_b128 v32, v[196:199] offset:0
    s_waitcnt lgkmcnt(2)
    buffer_store_dwordx4 v[224:227], v46, s[56:59], s64 offen sc1
    s_add_u32 s64, s64, 0x8000
    v_mfma_f32_16x16x32_bf16 v[216:219], v[72:75], v[112:115], v[216:219]
    ds_write_b128 v32, v[212:215] offset:64
    s_waitcnt lgkmcnt(2)
    buffer_store_dwordx4 v[240:243], v46, s[56:59], s64 offen sc1
    s_add_u32 s64, s64, 0x8000
    v_mfma_f32_16x16x32_bf16 v[216:219], v[76:79], v[116:119], v[216:219]
    ds_write_b128 v32, v[228:231] offset:128
    v_mfma_f32_16x16x32_bf16 v[232:235], v[80:83], v[112:115], v[232:235]
    ds_write_b128 v32, v[244:247] offset:192
    ds_read_b128 v[196:199], v33 offset:0
    v_mfma_f32_16x16x32_bf16 v[232:235], v[84:87], v[116:119], v[232:235]
    ds_read_b128 v[212:215], v33 offset:1088
    ds_read_b128 v[228:231], v33 offset:2176
    v_mfma_f32_16x16x32_bf16 v[248:251], v[88:91], v[112:115], v[248:251]
    ds_read_b128 v[244:247], v33 offset:3264
    v_mfma_f32_16x16x32_bf16 v[248:251], v[92:95], v[116:119], v[248:251]
    s_waitcnt lgkmcnt(3)
    buffer_store_dwordx4 v[196:199], v46, s[56:59], s65 offen sc1
    s_add_u32 s65, s65, 0x8000
    s_waitcnt lgkmcnt(15)
    v_mfma_f32_16x16x32_bf16 v[200:203], v[128:131], v[176:179], v[200:203]
    s_waitcnt lgkmcnt(2)
    buffer_store_dwordx4 v[212:215], v46, s[56:59], s65 offen sc1
    s_add_u32 s65, s65, 0x8000
    v_mfma_f32_16x16x32_bf16 v[200:203], v[132:135], v[180:183], v[200:203]
    s_waitcnt lgkmcnt(1)
    buffer_store_dwordx4 v[228:231], v46, s[56:59], s65 offen sc1
    s_add_u32 s65, s65, 0x8000
    v_mfma_f32_16x16x32_bf16 v[216:219], v[136:139], v[176:179], v[216:219]
    s_waitcnt lgkmcnt(0)
    buffer_store_dwordx4 v[244:247], v46, s[56:59], s65 offen sc1
    s_add_u32 s65, s65, 0x8000
    v_mfma_f32_16x16x32_bf16 v[216:219], v[140:143], v[180:183], v[216:219]
    v_mfma_f32_16x16x32_bf16 v[232:235], v[144:147], v[176:179], v[232:235]
    v_mfma_f32_16x16x32_bf16 v[232:235], v[148:151], v[180:183], v[232:235]
    v_mfma_f32_16x16x32_bf16 v[248:251], v[152:155], v[176:179], v[248:251]
    v_mfma_f32_16x16x32_bf16 v[248:251], v[156:159], v[180:183], v[248:251]
    v_mfma_f32_16x16x32_bf16 v[204:207], v[64:67], v[120:123], v[204:207]
    v_mfma_f32_16x16x32_bf16 v[204:207], v[68:71], v[124:127], v[204:207]
    ds_write_b128 v32, v[200:203] offset:0
    v_mfma_f32_16x16x32_bf16 v[220:223], v[72:75], v[120:123], v[220:223]
    ds_write_b128 v32, v[216:219] offset:64
    v_mfma_f32_16x16x32_bf16 v[220:223], v[76:79], v[124:127], v[220:223]
    ds_write_b128 v32, v[232:235] offset:128
    v_mfma_f32_16x16x32_bf16 v[236:239], v[80:83], v[120:123], v[236:239]
    ds_write_b128 v32, v[248:251] offset:192
    ds_read_b128 v[200:203], v33 offset:0
    v_mfma_f32_16x16x32_bf16 v[236:239], v[84:87], v[124:127], v[236:239]
    ds_read_b128 v[216:219], v33 offset:1088
    ds_read_b128 v[232:235], v33 offset:2176
    v_mfma_f32_16x16x32_bf16 v[252:255], v[88:91], v[120:123], v[252:255]
    ds_read_b128 v[248:251], v33 offset:3264
    v_mfma_f32_16x16x32_bf16 v[252:255], v[92:95], v[124:127], v[252:255]
    s_waitcnt lgkmcnt(3)
    buffer_store_dwordx4 v[200:203], v46, s[56:59], s66 offen sc1
    s_add_u32 s66, s66, 0x8000
    s_waitcnt lgkmcnt(15)
    v_mfma_f32_16x16x32_bf16 v[204:207], v[128:131], v[184:187], v[204:207]
    s_waitcnt lgkmcnt(2)
    buffer_store_dwordx4 v[216:219], v46, s[56:59], s66 offen sc1
    s_add_u32 s66, s66, 0x8000
    v_mfma_f32_16x16x32_bf16 v[204:207], v[132:135], v[188:191], v[204:207]
    s_waitcnt lgkmcnt(1)
    buffer_store_dwordx4 v[232:235], v46, s[56:59], s66 offen sc1
    s_add_u32 s66, s66, 0x8000
    v_mfma_f32_16x16x32_bf16 v[220:223], v[136:139], v[184:187], v[220:223]
    s_waitcnt lgkmcnt(0)
    buffer_store_dwordx4 v[248:251], v46, s[56:59], s66 offen sc1
    s_add_u32 s66, s66, 0x8000
    v_mfma_f32_16x16x32_bf16 v[220:223], v[140:143], v[188:191], v[220:223]
    v_mfma_f32_16x16x32_bf16 v[236:239], v[144:147], v[184:187], v[236:239]
    v_mfma_f32_16x16x32_bf16 v[236:239], v[148:151], v[188:191], v[236:239]
    v_mfma_f32_16x16x32_bf16 v[252:255], v[152:155], v[184:187], v[252:255]
    v_mfma_f32_16x16x32_bf16 v[252:255], v[156:159], v[188:191], v[252:255]
    s_nop 4
    ds_write_b128 v32, v[204:207] offset:0
    ds_write_b128 v32, v[220:223] offset:64
    ds_write_b128 v32, v[236:239] offset:128
    ds_write_b128 v32, v[252:255] offset:192
    ds_read_b128 v[204:207], v33 offset:0
    ds_read_b128 v[220:223], v33 offset:1088
    ds_read_b128 v[236:239], v33 offset:2176
    ds_read_b128 v[252:255], v33 offset:3264
    s_waitcnt lgkmcnt(3)
    buffer_store_dwordx4 v[204:207], v46, s[56:59], s67 offen sc1
    s_add_u32 s67, s67, 0x8000
    s_waitcnt lgkmcnt(2)
    buffer_store_dwordx4 v[220:223], v46, s[56:59], s67 offen sc1
    s_add_u32 s67, s67, 0x8000
    s_waitcnt lgkmcnt(1)
    buffer_store_dwordx4 v[236:239], v46, s[56:59], s67 offen sc1
    s_add_u32 s67, s67, 0x8000
    s_waitcnt lgkmcnt(0)
    buffer_store_dwordx4 v[252:255], v46, s[56:59], s67 offen sc1
    s_add_u32 s67, s67, 0x8000
    s_branch L_qend_58
L_hk_86:
    s_cmp_eq_u32 s70, 11
    s_cbranch_scc1 L_hn_96
    s_cmp_eq_u32 s70, 12
    s_cbranch_scc1 L_hn_97
L_hn_95:
    v_min_u32 v8, 0, v0
    v_lshlrev_b32 v8, 2, v8
    buffer_load_dword v9, v8, s[60:63], 0 offen sc1
    s_branch L_hkr_87
L_hn_96:
    v_cmp_ne_u32 vcc, 1, v9
    s_mov_b64 s[100:101], -1
    s_and_b64 vcc, vcc, s[100:101]
    s_cbranch_scc1 L_spin_98
L_spinr_99:
    s_branch L_hkr_87
L_hn_97:
    v_lshlrev_b32 v10, 4, v0
    buffer_load_dwordx4 v[12:15], v10, s[40:43], 0 offen sc1
    s_branch L_hkr_87
L_spin_88:
    s_mov_b32 s76, 400000
L_sp_100:
    s_sleep 1
    buffer_load_dwordx4 v[12:15], v10, s[40:43], 0 offen sc1
    s_waitcnt vmcnt(0)
    v_and_b32 v12, v12, v13
    v_and_b32 v14, v14, v15
    v_and_b32 v12, v12, v14
    v_cmp_ne_u32 vcc, 1, v12
    s_mov_b64 s[100:101], -1
    s_and_b64 vcc, vcc, s[100:101]
    s_cbranch_scc0 L_spinr_89
    s_sub_u32 s76, s76, 1
    s_cmp_lg_u32 s76, 0
    s_cbranch_scc1 L_sp_100
    s_branch L_spinr_89
L_spin_91:
    s_mov_b32 s76, 400000
L_sp_101:
    s_sleep 1
    buffer_load_dword v9, v8, s[40:43], s77 offen sc1
    s_waitcnt vmcnt(0)
    v_cmp_ne_u32 vcc, 1, v9
    s_mov_b64 s[100:101], -1
    s_and_b64 vcc, vcc, s[100:101]
    s_cbranch_scc0 L_spinr_92
    s_sub_u32 s76, s76, 1
    s_cmp_lg_u32 s76, 0
    s_cbranch_scc1 L_sp_101
    s_branch L_spinr_92
L_spin_98:
    s_mov_b32 s76, 400000
L_sp_102:
    s_sleep 1
    buffer_load_dword v9, v8, s[60:63], 0 offen sc1
    s_waitcnt vmcnt(0)
    v_cmp_ne_u32 vcc, 1, v9
    s_mov_b64 s[100:101], -1
    s_and_b64 vcc, vcc, s[100:101]
    s_cbranch_scc0 L_spinr_99
    s_sub_u32 s76, s76, 1
    s_cmp_lg_u32 s76, 0
    s_cbranch_scc1 L_sp_102
    s_branch L_spinr_99
L_qend_58:
L_fin:
L_exit:
    s_endpgm
.section .rodata,"a"
.p2align 6
.amdhsa_kernel concat_heads__ssm_conv_s5__grouped_kv_mqa__prompt_kernel
  .amdhsa_next_free_vgpr 256
  .amdhsa_next_free_sgpr 102
  .amdhsa_accum_offset 256
  .amdhsa_group_segment_fixed_size 0
  .amdhsa_kernarg_size 136
  .amdhsa_user_sgpr_count 2
  .amdhsa_user_sgpr_kernarg_segment_ptr 1
  .amdhsa_system_sgpr_workgroup_id_x 1
  .amdhsa_float_denorm_mode_32 3
.end_amdhsa_kernel
```
